```python
import torch

def _softmax(x, axis=-1):
    return torch.softmax(x, dim=axis)
def _gelu(x):
    return torch.nn.functional.gelu(x, approximate="tanh")
def _silu(x):
    return torch.nn.functional.silu(x)
def _sigmoid(x):
    return torch.sigmoid(x)
def _layernorm(x, axis=-1, eps=1e-5):
    m = x.mean(dim=axis, keepdim=True)
    v = x.var(dim=axis, keepdim=True, unbiased=False)
    return (x - m) / torch.sqrt(v + eps)
def _scatter_add(tgt, idx, src, axis=0):
    return tgt.clone().index_add_(axis, idx, src)
def _segment_sum(src, seg, n):
    out = torch.zeros((n,) + src.shape[1:], dtype=src.dtype)
    return out.index_add_(0, seg, src)
def _pad(x, pw):
    flat = tuple(v for pair in reversed(pw) for v in pair)
    return torch.nn.functional.pad(x, flat)

kernel_name = 'parallel_sum__grouped_kv_mqa__dense_activation_gelu__prompt'

def setup_inputs():

    _w = (lambda a: (lambda t: t.to(torch.bfloat16) if t.is_floating_point() else t)(torch.as_tensor(a)))
    def _A_setup():
        B, S, D, H = 1, 2048, 512, 32
        Dh = D // H
        return {
            "x": _w((lambda *s: torch.randn(*s, dtype=torch.bfloat16) * 0.05)(B, S, D)),
            "wq": _w((lambda *s: torch.randn(*s, dtype=torch.bfloat16) * 0.05)(D, H * Dh)),
            "wk": _w((lambda *s: torch.randn(*s, dtype=torch.bfloat16) * 0.05)(D, Dh)),
            "wv": _w((lambda *s: torch.randn(*s, dtype=torch.bfloat16) * 0.05)(D, Dh)),
            "wo": _w((lambda *s: torch.randn(*s, dtype=torch.bfloat16) * 0.05)(H * Dh, D)),
        }
    _A_in = _A_setup()

    def _B_setup():
        B, S, D, F = 1, 2048, 512, 1792
        return {
            "x": _w((lambda *s: torch.randn(*s, dtype=torch.bfloat16) * 0.05)(B, S, D)),
            "w1": _w((lambda *s: torch.randn(*s, dtype=torch.bfloat16) * 0.8)(D, F) * (D ** -0.5)),
            "b1": _w((lambda *s: torch.randn(*s, dtype=torch.bfloat16) * 12.8)(F) * 0.01),
            "w2": _w((lambda *s: torch.randn(*s, dtype=torch.bfloat16) * 0.8)(F, D) * (F ** -0.5)),
            "b2": _w((lambda *s: torch.randn(*s, dtype=torch.bfloat16) * 12.8)(D) * 0.01),
        }
    _B_in = _B_setup()

    return {
        "A_x": _A_in["x"],
        "A_wq": _A_in["wq"],
        "A_wk": _A_in["wk"],
        "A_wv": _A_in["wv"],
        "A_wo": _A_in["wo"],
        "B_x": _B_in["x"],
        "B_w1": _B_in["w1"],
        "B_b1": _B_in["b1"],
        "B_w2": _B_in["w2"],
        "B_b2": _B_in["b2"],
    }

def reference(A_x, A_wq, A_wk, A_wv, A_wo, B_x, B_w1, B_b1, B_w2, B_b2):
    def _A_ref(x, wq, wk, wv, wo):
        B, S, D = x.shape
        H = 32
        Dh = D // H
        q = (lambda x, *d: x.permute(*d))((x @ wq).reshape(B, S, H, Dh), 0, 2, 1, 3)
        k = x @ wk
        v = x @ wv
        scores = torch.einsum("bhqd,bkd->bhqk", q, k) * (Dh ** -0.5)
        p = _softmax(scores, axis=-1)
        o = torch.einsum("bhqk,bkd->bhqd", p, v)
        return (lambda x, *d: x.permute(*d))(o, 0, 2, 1, 3).reshape(B, S, H * Dh) @ wo

    def _B_ref(x, w1, b1, w2, b2):
        h = torch.einsum("bsd,df->bsf", x, w1) + b1
        h = _gelu(h)
        return torch.einsum("bsf,fd->bsd", h, w2) + b2

    x = A_x
    xn = _layernorm(x, axis=-1)
    return x + _A_ref(xn, A_wq, A_wk, A_wv, A_wo) + _B_ref(xn, B_w1, B_b1, B_w2, B_b2)
```

```asm
; @launch grid=(256,1,1) block=(768,1,1) lds=158080
.amdgcn_target "amdgcn-amd-amdhsa--gfx950"
.text
.globl parallel_sum__grouped_kv_mqa__dense_activation_gelu__prompt_kernel
.p2align 8
.type parallel_sum__grouped_kv_mqa__dense_activation_gelu__prompt_kernel,@function
parallel_sum__grouped_kv_mqa__dense_activation_gelu__prompt_kernel:
    s_cmp_ge_u32 s2, 256
    s_cbranch_scc1 L_end
    s_load_dwordx16 s[16:31], s[0:1], 0
    s_load_dwordx8 s[32:39], s[0:1], 64
    s_load_dwordx2 s[40:41], s[0:1], 96
    v_lshrrev_b32 v1, 6, v0
    v_and_b32 v0, 63, v0
    v_readfirstlane_b32 s3, v1
    s_cmp_lg_u32 s3, 11
    s_cbranch_scc1 L_nocpf_1
    s_getpc_b64 s[64:65]
L_pc_2:
    s_lshr_b32 s6, s2, 3
    v_and_b32 v2, 15, v0
    v_lshl_add_u32 v2, v2, 5, s6
    v_min_u32 v2, (L_code_end-L_pc_2)/128, v2
    v_lshlrev_b32 v2, 7, v2
    v_mov_b32 v3, s65
    v_add_co_u32 v2, vcc, s64, v2
    s_nop 1
    v_addc_co_u32 v3, vcc, 0, v3, vcc
    global_load_dword v150, v[2:3], off
L_nocpf_1:
    s_lshr_b32 s6, s2, 3
    s_add_u32 s4, s6, 0
    s_and_b32 s4, s4, 7
    s_lshr_b32 s6, s6, 3
    s_and_b32 s5, s2, 7
    s_lshl_b32 s5, s5, 2
    s_add_u32 s5, s5, s6
    s_lshl_b32 s42, s5, 3
    s_add_u32 s42, s42, s4
    s_mov_b32 s86, 0x100000
    s_cmp_ge_u32 s3, 8
    s_cbranch_scc1 L_G
    s_cmp_ge_u32 s3, 6
    s_cbranch_scc1 L_stg_4
    s_cmp_ge_u32 s3, 4
    s_cbranch_scc1 L_kvw_3
    s_setprio 1
    v_lshrrev_b32 v1, 3, v0
    v_and_b32 v2, 7, v0
    v_lshlrev_b32 v3, 10, v1
    v_lshl_add_u32 v3, v2, 4, v3
    s_and_b32 s6, s4, 6
    s_add_u32 s87, s3, s6
    s_add_u32 s87, s87, 4
    s_and_b32 s87, s87, 7
    s_lshl_b32 s6, s5, 3
    s_add_u32 s6, s6, s87
    s_lshl_b32 s81, s6, 13
    s_mov_b32 s46, 2097152
    s_mov_b32 s47, 0x20000
    s_barrier
    s_waitcnt lgkmcnt(0)
    s_mov_b32 s44, s16
    s_mov_b32 s45, s17
    s_lshl_b32 s15, s4, 7
    s_add_u32 s13, s81, s15
    s_add_u32 s15, s15, 128
    s_and_b32 s15, s15, 0x3ff
    buffer_load_dwordx4 v[72:75], v3, s[44:47], s13 offen nt
    s_add_u32 s13, s81, s15
    s_add_u32 s15, s15, 128
    s_and_b32 s15, s15, 0x3ff
    buffer_load_dwordx4 v[76:79], v3, s[44:47], s13 offen nt
    s_add_u32 s13, s81, s15
    s_add_u32 s15, s15, 128
    s_and_b32 s15, s15, 0x3ff
    buffer_load_dwordx4 v[80:83], v3, s[44:47], s13 offen nt
    s_add_u32 s13, s81, s15
    s_add_u32 s15, s15, 128
    s_and_b32 s15, s15, 0x3ff
    buffer_load_dwordx4 v[84:87], v3, s[44:47], s13 offen nt
    s_add_u32 s13, s81, s15
    s_add_u32 s15, s15, 128
    s_and_b32 s15, s15, 0x3ff
    buffer_load_dwordx4 v[88:91], v3, s[44:47], s13 offen nt
    s_add_u32 s13, s81, s15
    s_add_u32 s15, s15, 128
    s_and_b32 s15, s15, 0x3ff
    buffer_load_dwordx4 v[92:95], v3, s[44:47], s13 offen nt
    s_add_u32 s13, s81, s15
    s_add_u32 s15, s15, 128
    s_and_b32 s15, s15, 0x3ff
    buffer_load_dwordx4 v[96:99], v3, s[44:47], s13 offen nt
    s_add_u32 s13, s81, s15
    s_add_u32 s15, s15, 128
    s_and_b32 s15, s15, 0x3ff
    buffer_load_dwordx4 v[100:103], v3, s[44:47], s13 offen nt
    s_mov_b32 s48, s40
    s_mov_b32 s49, s41
    s_mov_b32 s50, 0x1000000
    s_mov_b32 s51, 0x20000
    s_and_b32 s10, s3, 3
    s_lshr_b32 s11, s3, 2
    v_lshlrev_b32 v162, 4, v0
    s_lshr_b32 s7, s10, 1
    s_lshl1_add_u32 s6, s5, s7
    s_lshl_b32 s6, s6, 5
    s_lshl2_add_u32 s6, s4, s6
    s_lshl1_add_u32 s6, s11, s6
    s_and_b32 s7, s10, 1
    s_add_u32 s6, s6, s7
    s_lshl_b32 s6, s6, 10
    s_add_u32 s79, s6, 3145728
    s_mov_b32 s64, 0x3f803f80
    s_mov_b32 s65, 0x00003f80
    s_mov_b32 s66, 0x3f800000
    s_lshr_b32 s7, s87, 2
    s_mul_i32 s7, s7, 33792
    s_and_b32 s8, s87, 3
    s_lshl_b32 s8, s8, 7
    s_add_u32 s7, s7, s8
    v_lshrrev_b32 v4, 1, v2
    v_mul_u32_u24 v4, 1056, v4
    v_and_b32 v5, 1, v2
    v_mul_u32_u24 v5, 528, v5
    v_add3_u32 v4, v4, v5, s7
    v_lshl_add_u32 v4, v1, 4, v4
    s_lshl_b32 s8, s87, 5
    s_add_u32 s8, s8, 149504
    v_lshl_add_u32 v5, v1, 2, s8
    v_mov_b32 v166, 157952
    v_lshrrev_b32 v6, 5, v0
    v_and_b32 v7, 15, v0
    v_lshlrev_b32 v6, 8, v6
    v_lshl_add_u32 v163, v7, 4, v6
    v_mul_u32_u24 v160, 16, v0
    v_mov_b32 v165, 0x100
    s_lshr_b32 s6, s10, 1
    s_lshl_b32 s7, s6, 6
    s_and_b32 s8, s10, 1
    s_mul_i32 s9, s8, 33792
    v_lshrrev_b32 v156, 5, v0
    v_lshlrev_b32 v156, 10, v156
    v_bfe_u32 v6, v0, 2, 2
    v_lshl_add_u32 v156, v6, 7, v156
    v_lshrrev_b32 v6, 1, v6
    v_lshl_add_u32 v156, v6, 6, v156
    v_bfe_u32 v6, v0, 4, 1
    v_lshl_add_u32 v156, v6, 5, v156
    v_and_b32 v6, 3, v0
    v_lshl_add_u32 v156, v6, 3, v156
    v_xor_b32 v156, s7, v156
    v_add_u32 v156, 67584, v156
    v_lshrrev_b32 v6, 5, v0
    v_mul_u32_u24 v6, 528, v6
    v_and_b32 v157, 31, v0
    v_lshl_add_u32 v157, v157, 4, v6
    v_add_u32 v157, s9, v157
    v_and_b32 v6, 31, v0
    s_lshl_b32 s9, s8, 7
    s_add_u32 s9, s9, 149504
    v_lshl_add_u32 v158, v6, 2, s9
    s_lshl_b32 s8, s8, 1
    s_lshl_b32 s6, s6, 2
    s_add_u32 s6, s6, s8
    s_lshl_b32 s6, s6, 10
    s_add_u32 s6, s6, 149760
    v_add_u32 v159, s6, v162
    s_branch L_ln_5
L_stg_4:
    s_setprio 3
    v_lshlrev_b32 v162, 4, v0
    s_and_b32 s12, s5, 3
    s_lshr_b32 s6, s4, 1
    s_lshl2_add_u32 s12, s12, s6
    s_and_b32 s6, s3, 1
    s_add_u32 s12, s12, s6
    s_lshl_b32 s12, s12, 10
    v_lshrrev_b32 v1, 3, v0
    v_and_b32 v2, 7, v0
    v_lshlrev_b32 v3, 10, v1
    v_lshl_add_u32 v3, v2, 4, v3
    s_and_b32 s6, s4, 6
    s_add_u32 s87, s3, s6
    s_add_u32 s87, s87, 4
    s_and_b32 s87, s87, 7
    s_lshl_b32 s6, s5, 3
    s_add_u32 s6, s6, s87
    s_lshl_b32 s81, s6, 13
    s_mov_b32 s46, 2097152
    s_mov_b32 s47, 0x20000
    s_barrier
    s_waitcnt lgkmcnt(0)
    s_mov_b32 s44, s16
    s_mov_b32 s45, s17
    s_mov_b32 s48, s40
    s_mov_b32 s49, s41
    s_mov_b32 s50, 0x1000000
    s_mov_b32 s51, 0x20000
    s_bitcmp1_b32 s4, 0
    s_cselect_b32 s56, s22, s20
    s_cselect_b32 s57, s23, s21
    s_mov_b32 s58, 16384
    s_mov_b32 s59, 0x20000
    s_and_b32 s12, s12, 0x3fff
    s_add_u32 m0, s12, 133120
    s_mov_b32 s6, s12
    s_add_u32 s12, s12, 2048
    buffer_load_dwordx4 v162, s[56:59], s6 offen lds
    s_and_b32 s12, s12, 0x3fff
    s_add_u32 m0, s12, 133120
    s_mov_b32 s6, s12
    s_add_u32 s12, s12, 2048
    buffer_load_dwordx4 v162, s[56:59], s6 offen lds
    s_and_b32 s12, s12, 0x3fff
    s_add_u32 m0, s12, 133120
    s_mov_b32 s6, s12
    s_add_u32 s12, s12, 2048
    buffer_load_dwordx4 v162, s[56:59], s6 offen lds
    s_and_b32 s12, s12, 0x3fff
    s_add_u32 m0, s12, 133120
    s_mov_b32 s6, s12
    s_add_u32 s12, s12, 2048
    buffer_load_dwordx4 v162, s[56:59], s6 offen lds
    s_and_b32 s12, s12, 0x3fff
    s_add_u32 m0, s12, 133120
    s_mov_b32 s6, s12
    s_add_u32 s12, s12, 2048
    buffer_load_dwordx4 v162, s[56:59], s6 offen lds
    s_and_b32 s12, s12, 0x3fff
    s_add_u32 m0, s12, 133120
    s_mov_b32 s6, s12
    s_add_u32 s12, s12, 2048
    buffer_load_dwordx4 v162, s[56:59], s6 offen lds
    s_and_b32 s12, s12, 0x3fff
    s_add_u32 m0, s12, 133120
    s_mov_b32 s6, s12
    s_add_u32 s12, s12, 2048
    buffer_load_dwordx4 v162, s[56:59], s6 offen lds
    s_and_b32 s12, s12, 0x3fff
    s_add_u32 m0, s12, 133120
    s_mov_b32 s6, s12
    s_add_u32 s12, s12, 2048
    buffer_load_dwordx4 v162, s[56:59], s6 offen lds
    s_mov_b32 s6, 13762560
    buffer_load_dword v112, off, s[48:51], s6 sc1
    s_setprio 1
    s_lshl_b32 s15, s4, 7
    s_add_u32 s13, s81, s15
    s_add_u32 s15, s15, 128
    s_and_b32 s15, s15, 0x3ff
    buffer_load_dwordx4 v[72:75], v3, s[44:47], s13 offen nt
    s_add_u32 s13, s81, s15
    s_add_u32 s15, s15, 128
    s_and_b32 s15, s15, 0x3ff
    buffer_load_dwordx4 v[76:79], v3, s[44:47], s13 offen nt
    s_add_u32 s13, s81, s15
    s_add_u32 s15, s15, 128
    s_and_b32 s15, s15, 0x3ff
    buffer_load_dwordx4 v[80:83], v3, s[44:47], s13 offen nt
    s_add_u32 s13, s81, s15
    s_add_u32 s15, s15, 128
    s_and_b32 s15, s15, 0x3ff
    buffer_load_dwordx4 v[84:87], v3, s[44:47], s13 offen nt
    s_add_u32 s13, s81, s15
    s_add_u32 s15, s15, 128
    s_and_b32 s15, s15, 0x3ff
    buffer_load_dwordx4 v[88:91], v3, s[44:47], s13 offen nt
    s_add_u32 s13, s81, s15
    s_add_u32 s15, s15, 128
    s_and_b32 s15, s15, 0x3ff
    buffer_load_dwordx4 v[92:95], v3, s[44:47], s13 offen nt
    s_add_u32 s13, s81, s15
    s_add_u32 s15, s15, 128
    s_and_b32 s15, s15, 0x3ff
    buffer_load_dwordx4 v[96:99], v3, s[44:47], s13 offen nt
    s_add_u32 s13, s81, s15
    s_add_u32 s15, s15, 128
    s_and_b32 s15, s15, 0x3ff
    buffer_load_dwordx4 v[100:103], v3, s[44:47], s13 offen nt
    s_setprio 3
    s_mov_b32 s48, s40
    s_mov_b32 s49, s41
    s_mov_b32 s50, 0x1000000
    s_mov_b32 s51, 0x20000
    s_and_b32 s10, s3, 3
    s_lshr_b32 s11, s3, 2
    v_lshlrev_b32 v162, 4, v0
    s_lshr_b32 s7, s10, 1
    s_lshl1_add_u32 s6, s5, s7
    s_lshl_b32 s6, s6, 5
    s_lshl2_add_u32 s6, s4, s6
    s_lshl1_add_u32 s6, s11, s6
    s_and_b32 s7, s10, 1
    s_add_u32 s6, s6, s7
    s_lshl_b32 s6, s6, 10
    s_add_u32 s79, s6, 3145728
    s_mov_b32 s64, 0x3f803f80
    s_mov_b32 s65, 0x00003f80
    s_mov_b32 s66, 0x3f800000
    s_lshr_b32 s7, s87, 2
    s_mul_i32 s7, s7, 33792
    s_and_b32 s8, s87, 3
    s_lshl_b32 s8, s8, 7
    s_add_u32 s7, s7, s8
    v_lshrrev_b32 v4, 1, v2
    v_mul_u32_u24 v4, 1056, v4
    v_and_b32 v5, 1, v2
    v_mul_u32_u24 v5, 528, v5
    v_add3_u32 v4, v4, v5, s7
    v_lshl_add_u32 v4, v1, 4, v4
    s_lshl_b32 s8, s87, 5
    s_add_u32 s8, s8, 149504
    v_lshl_add_u32 v5, v1, 2, s8
    v_mov_b32 v166, 157952
    v_lshrrev_b32 v6, 5, v0
    v_and_b32 v7, 15, v0
    v_lshlrev_b32 v6, 8, v6
    v_lshl_add_u32 v163, v7, 4, v6
    v_mul_u32_u24 v160, 16, v0
    v_mov_b32 v165, 0x100
    v_mov_b32 v159, 0
    s_waitcnt vmcnt(8)
    v_readfirstlane_b32 s43, v112
    v_mov_b32 v113, 1
    s_mul_i32 s43, s43, 0x9e3779b1
    s_add_u32 s43, s43, 0x6a09e667
    v_mov_b32 v112, s43
    ds_write_b32 v166, v112 offset:64
    s_waitcnt lgkmcnt(0)
    s_mov_b64 exec, 1
    ds_add_u32 v166, v113 offset:32
    s_mov_b64 exec, -1
    s_setprio 0
    s_branch L_ln_5
L_kvw_3:
    s_setprio 3
    v_lshrrev_b32 v1, 3, v0
    v_and_b32 v2, 7, v0
    v_lshlrev_b32 v3, 10, v1
    v_lshl_add_u32 v3, v2, 4, v3
    s_and_b32 s6, s4, 6
    s_add_u32 s87, s3, s6
    s_add_u32 s87, s87, 4
    s_and_b32 s87, s87, 7
    s_lshl_b32 s6, s5, 3
    s_add_u32 s6, s6, s87
    s_lshl_b32 s81, s6, 13
    s_mov_b32 s46, 2097152
    s_mov_b32 s47, 0x20000
    s_barrier
    s_waitcnt lgkmcnt(0)
    s_mov_b32 s44, s16
    s_mov_b32 s45, s17
    s_lshl_b32 s15, s4, 7
    s_add_u32 s13, s81, s15
    s_add_u32 s15, s15, 128
    s_and_b32 s15, s15, 0x3ff
    buffer_load_dwordx4 v[72:75], v3, s[44:47], s13 offen nt
    s_add_u32 s13, s81, s15
    s_add_u32 s15, s15, 128
    s_and_b32 s15, s15, 0x3ff
    buffer_load_dwordx4 v[76:79], v3, s[44:47], s13 offen nt
    s_add_u32 s13, s81, s15
    s_add_u32 s15, s15, 128
    s_and_b32 s15, s15, 0x3ff
    buffer_load_dwordx4 v[80:83], v3, s[44:47], s13 offen nt
    s_add_u32 s13, s81, s15
    s_add_u32 s15, s15, 128
    s_and_b32 s15, s15, 0x3ff
    buffer_load_dwordx4 v[84:87], v3, s[44:47], s13 offen nt
    s_add_u32 s13, s81, s15
    s_add_u32 s15, s15, 128
    s_and_b32 s15, s15, 0x3ff
    buffer_load_dwordx4 v[88:91], v3, s[44:47], s13 offen nt
    s_add_u32 s13, s81, s15
    s_add_u32 s15, s15, 128
    s_and_b32 s15, s15, 0x3ff
    buffer_load_dwordx4 v[92:95], v3, s[44:47], s13 offen nt
    s_add_u32 s13, s81, s15
    s_add_u32 s15, s15, 128
    s_and_b32 s15, s15, 0x3ff
    buffer_load_dwordx4 v[96:99], v3, s[44:47], s13 offen nt
    s_add_u32 s13, s81, s15
    s_add_u32 s15, s15, 128
    s_and_b32 s15, s15, 0x3ff
    buffer_load_dwordx4 v[100:103], v3, s[44:47], s13 offen nt
    s_mov_b32 s48, s40
    s_mov_b32 s49, s41
    s_mov_b32 s50, 0x1000000
    s_mov_b32 s51, 0x20000
    s_and_b32 s10, s3, 3
    s_lshr_b32 s11, s3, 2
    v_lshlrev_b32 v162, 4, v0
    s_lshr_b32 s7, s10, 1
    s_lshl1_add_u32 s6, s5, s7
    s_lshl_b32 s6, s6, 5
    s_lshl2_add_u32 s6, s4, s6
    s_lshl1_add_u32 s6, s11, s6
    s_and_b32 s7, s10, 1
    s_add_u32 s6, s6, s7
    s_lshl_b32 s6, s6, 10
    s_add_u32 s79, s6, 3145728
    s_mov_b32 s64, 0x3f803f80
    s_mov_b32 s65, 0x00003f80
    s_mov_b32 s66, 0x3f800000
    s_lshr_b32 s7, s87, 2
    s_mul_i32 s7, s7, 33792
    s_and_b32 s8, s87, 3
    s_lshl_b32 s8, s8, 7
    s_add_u32 s7, s7, s8
    v_lshrrev_b32 v4, 1, v2
    v_mul_u32_u24 v4, 1056, v4
    v_and_b32 v5, 1, v2
    v_mul_u32_u24 v5, 528, v5
    v_add3_u32 v4, v4, v5, s7
    v_lshl_add_u32 v4, v1, 4, v4
    s_lshl_b32 s8, s87, 5
    s_add_u32 s8, s8, 149504
    v_lshl_add_u32 v5, v1, 2, s8
    v_mov_b32 v166, 157952
    v_lshrrev_b32 v6, 5, v0
    v_and_b32 v7, 15, v0
    v_lshlrev_b32 v6, 8, v6
    v_lshl_add_u32 v163, v7, 4, v6
    v_mul_u32_u24 v160, 16, v0
    v_mov_b32 v165, 0x101
    s_lshr_b32 s6, s4, 2
    s_mul_i32 s7, s6, 33792
    s_lshl_b32 s78, s5, 1
    s_add_u32 s78, s78, s6
    s_lshl_b32 s78, s78, 11
    s_bfe_u32 s8, s4, 0x10001
    s_lshl_b32 s9, s8, 8
    s_add_u32 s7, s7, s9
    v_lshrrev_b32 v6, 4, v0
    v_and_b32 v7, 15, v0
    v_lshrrev_b32 v104, 1, v6
    v_and_b32 v105, 1, v6
    v_mul_u32_u24 v106, 1056, v104
    v_mul_u32_u24 v107, 528, v105
    v_add3_u32 v106, v106, v107, s7
    v_lshl_add_u32 v157, v7, 4, v106
    v_lshlrev_b32 v106, 8, v6
    v_lshl_add_u32 v106, v7, 3, v106
    v_add_u32 v156, 133120, v106
    s_lshr_b32 s6, s4, 1
    s_lshl_b32 s6, s6, 6
    s_add_u32 s6, s6, 149504
    s_bitcmp1_b32 s4, 0
    s_cbranch_scc1 L_setv_6
    v_lshl_add_u32 v158, v7, 2, s6
    v_lshlrev_b32 v106, 9, v105
    v_lshl_add_u32 v106, v7, 4, v106
    v_lshl_add_u32 v159, v104, 3, v106
    s_add_u32 s78, s78, s9
    s_branch L_sete_7
L_setv_6:
    v_lshl_add_u32 v158, v6, 4, s6
    v_lshlrev_b32 v106, 8, v104
    v_lshl_add_u32 v106, v7, 4, v106
    v_lshl_add_u32 v159, v105, 3, v106
    s_lshl_b32 s8, s8, 9
    s_add_u32 s78, s78, s8
    s_add_u32 s78, s78, 1024
L_sete_7:
L_ln_5:
    s_mov_b32 s52, s34
    s_mov_b32 s53, s35
    s_mov_b32 s54, 0x400
    s_mov_b32 s55, 0x20000
    v_lshlrev_b32 v7, 4, v2
    s_lshl_b32 s8, s4, 7
    buffer_load_dwordx4 v[148:151], v7, s[52:55], s8 offen
    s_waitcnt vmcnt(8)
    v_dot2_f32_bf16 v6, v72, s64, 0
    v_dot2_f32_bf16 v7, v72, v72, 0
    v_dot2_f32_bf16 v6, v73, s64, v6
    v_dot2_f32_bf16 v7, v73, v73, v7
    v_dot2_f32_bf16 v6, v74, s64, v6
    v_dot2_f32_bf16 v7, v74, v74, v7
    v_dot2_f32_bf16 v6, v75, s64, v6
    v_dot2_f32_bf16 v7, v75, v75, v7
    s_waitcnt vmcnt(7)
    v_dot2_f32_bf16 v6, v76, s64, v6
    v_dot2_f32_bf16 v7, v76, v76, v7
    v_dot2_f32_bf16 v6, v77, s64, v6
    v_dot2_f32_bf16 v7, v77, v77, v7
    v_dot2_f32_bf16 v6, v78, s64, v6
    v_dot2_f32_bf16 v7, v78, v78, v7
    v_dot2_f32_bf16 v6, v79, s64, v6
    v_dot2_f32_bf16 v7, v79, v79, v7
    s_waitcnt vmcnt(6)
    v_dot2_f32_bf16 v6, v80, s64, v6
    v_dot2_f32_bf16 v7, v80, v80, v7
    v_dot2_f32_bf16 v6, v81, s64, v6
    v_dot2_f32_bf16 v7, v81, v81, v7
    v_dot2_f32_bf16 v6, v82, s64, v6
    v_dot2_f32_bf16 v7, v82, v82, v7
    v_dot2_f32_bf16 v6, v83, s64, v6
    v_dot2_f32_bf16 v7, v83, v83, v7
    s_waitcnt vmcnt(5)
    v_dot2_f32_bf16 v6, v84, s64, v6
    v_dot2_f32_bf16 v7, v84, v84, v7
    v_dot2_f32_bf16 v6, v85, s64, v6
    v_dot2_f32_bf16 v7, v85, v85, v7
    v_dot2_f32_bf16 v6, v86, s64, v6
    v_dot2_f32_bf16 v7, v86, v86, v7
    v_dot2_f32_bf16 v6, v87, s64, v6
    v_dot2_f32_bf16 v7, v87, v87, v7
    s_waitcnt vmcnt(4)
    v_dot2_f32_bf16 v6, v88, s64, v6
    v_dot2_f32_bf16 v7, v88, v88, v7
    v_dot2_f32_bf16 v6, v89, s64, v6
    v_dot2_f32_bf16 v7, v89, v89, v7
    v_dot2_f32_bf16 v6, v90, s64, v6
    v_dot2_f32_bf16 v7, v90, v90, v7
    v_dot2_f32_bf16 v6, v91, s64, v6
    v_dot2_f32_bf16 v7, v91, v91, v7
    s_waitcnt vmcnt(3)
    v_dot2_f32_bf16 v6, v92, s64, v6
    v_dot2_f32_bf16 v7, v92, v92, v7
    v_dot2_f32_bf16 v6, v93, s64, v6
    v_dot2_f32_bf16 v7, v93, v93, v7
    v_dot2_f32_bf16 v6, v94, s64, v6
    v_dot2_f32_bf16 v7, v94, v94, v7
    v_dot2_f32_bf16 v6, v95, s64, v6
    v_dot2_f32_bf16 v7, v95, v95, v7
    s_waitcnt vmcnt(2)
    v_dot2_f32_bf16 v6, v96, s64, v6
    v_dot2_f32_bf16 v7, v96, v96, v7
    v_dot2_f32_bf16 v6, v97, s64, v6
    v_dot2_f32_bf16 v7, v97, v97, v7
    v_dot2_f32_bf16 v6, v98, s64, v6
    v_dot2_f32_bf16 v7, v98, v98, v7
    v_dot2_f32_bf16 v6, v99, s64, v6
    v_dot2_f32_bf16 v7, v99, v99, v7
    s_waitcnt vmcnt(1)
    v_dot2_f32_bf16 v6, v100, s64, v6
    v_dot2_f32_bf16 v7, v100, v100, v7
    v_dot2_f32_bf16 v6, v101, s64, v6
    v_dot2_f32_bf16 v7, v101, v101, v7
    v_dot2_f32_bf16 v6, v102, s64, v6
    v_dot2_f32_bf16 v7, v102, v102, v7
    v_dot2_f32_bf16 v6, v103, s64, v6
    v_dot2_f32_bf16 v7, v103, v103, v7
    v_mov_b32 v152, v72
    v_mov_b32 v153, v73
    v_mov_b32 v154, v74
    v_mov_b32 v155, v75
    s_nop 0
    v_add_f32_dpp v6, v6, v6 quad_perm:[1,0,3,2] row_mask:0xf bank_mask:0xf
    v_add_f32_dpp v7, v7, v7 quad_perm:[1,0,3,2] row_mask:0xf bank_mask:0xf
    s_nop 0
    v_add_f32_dpp v6, v6, v6 quad_perm:[2,3,0,1] row_mask:0xf bank_mask:0xf
    v_add_f32_dpp v7, v7, v7 quad_perm:[2,3,0,1] row_mask:0xf bank_mask:0xf
    s_nop 0
    v_add_f32_dpp v6, v6, v6 row_half_mirror row_mask:0xf bank_mask:0xf
    v_add_f32_dpp v7, v7, v7 row_half_mirror row_mask:0xf bank_mask:0xf
    v_mul_f32 v6, 0xbb000000, v6
    v_mul_f32 v7, 0x3b000000, v7
    v_fma_f32 v7, -v6, v6, v7
    v_cvt_pk_bf16_f32 v6, v6, v6
    v_lshlrev_b32 v6, 16, v6
    v_dot2_f32_bf16 v104, v72, s65, v6
    v_dot2_f32_bf16 v105, v72, s66, v6
    v_max_f32 v7, 0, v7
    v_dot2_f32_bf16 v106, v73, s65, v6
    v_dot2_f32_bf16 v107, v73, s66, v6
    v_cvt_pk_bf16_f32 v7, v7, v7
    v_dot2_f32_bf16 v108, v74, s65, v6
    v_dot2_f32_bf16 v109, v74, s66, v6
    v_cvt_pk_bf16_f32 v72, v104, v105
    v_lshlrev_b32 v7, 16, v7
    v_dot2_f32_bf16 v110, v75, s65, v6
    v_dot2_f32_bf16 v111, v75, s66, v6
    v_cvt_pk_bf16_f32 v73, v106, v107
    v_add_f32 v7, 0x3727c5ac, v7
    v_dot2_f32_bf16 v104, v76, s65, v6
    v_dot2_f32_bf16 v105, v76, s66, v6
    v_cvt_pk_bf16_f32 v74, v108, v109
    v_cvt_pk_bf16_f32 v7, v7, v7
    v_dot2_f32_bf16 v106, v77, s65, v6
    v_dot2_f32_bf16 v107, v77, s66, v6
    v_cvt_pk_bf16_f32 v75, v110, v111
    s_add_u32 s6, s4, 0
    s_and_b32 s6, s6, 7
    s_mul_i32 s6, s6, 4224
    v_add_u32 v3, s6, v4
    ds_write_b128 v3, v[72:75] offset:0
    v_lshlrev_b32 v7, 16, v7
    v_dot2_f32_bf16 v108, v78, s65, v6
    v_dot2_f32_bf16 v109, v78, s66, v6
    v_cvt_pk_bf16_f32 v76, v104, v105
    v_sqrt_f32 v7, v7
    v_dot2_f32_bf16 v110, v79, s65, v6
    v_dot2_f32_bf16 v111, v79, s66, v6
    v_cvt_pk_bf16_f32 v77, v106, v107
    v_cvt_pk_bf16_f32 v7, v7, v7
    v_dot2_f32_bf16 v104, v80, s65, v6
    v_dot2_f32_bf16 v105, v80, s66, v6
    v_cvt_pk_bf16_f32 v78, v108, v109
    v_lshlrev_b32 v7, 16, v7
    v_dot2_f32_bf16 v106, v81, s65, v6
    v_dot2_f32_bf16 v107, v81, s66, v6
    v_cvt_pk_bf16_f32 v79, v110, v111
    s_add_u32 s6, s4, 1
    s_and_b32 s6, s6, 7
    s_mul_i32 s6, s6, 4224
    v_add_u32 v3, s6, v4
    ds_write_b128 v3, v[76:79] offset:0
    v_rcp_f32 v7, v7
    v_dot2_f32_bf16 v108, v82, s65, v6
    v_dot2_f32_bf16 v109, v82, s66, v6
    v_cvt_pk_bf16_f32 v80, v104, v105
    ds_write_b32 v5, v7
    v_dot2_f32_bf16 v110, v83, s65, v6
    v_dot2_f32_bf16 v111, v83, s66, v6
    v_cvt_pk_bf16_f32 v81, v106, v107
    v_dot2_f32_bf16 v104, v84, s65, v6
    v_dot2_f32_bf16 v105, v84, s66, v6
    v_cvt_pk_bf16_f32 v82, v108, v109
    v_dot2_f32_bf16 v106, v85, s65, v6
    v_dot2_f32_bf16 v107, v85, s66, v6
    v_cvt_pk_bf16_f32 v83, v110, v111
    s_add_u32 s6, s4, 2
    s_and_b32 s6, s6, 7
    s_mul_i32 s6, s6, 4224
    v_add_u32 v3, s6, v4
    ds_write_b128 v3, v[80:83] offset:0
    v_dot2_f32_bf16 v108, v86, s65, v6
    v_dot2_f32_bf16 v109, v86, s66, v6
    v_cvt_pk_bf16_f32 v84, v104, v105
    v_dot2_f32_bf16 v110, v87, s65, v6
    v_dot2_f32_bf16 v111, v87, s66, v6
    v_cvt_pk_bf16_f32 v85, v106, v107
    v_dot2_f32_bf16 v104, v88, s65, v6
    v_dot2_f32_bf16 v105, v88, s66, v6
    v_cvt_pk_bf16_f32 v86, v108, v109
    v_dot2_f32_bf16 v106, v89, s65, v6
    v_dot2_f32_bf16 v107, v89, s66, v6
    v_cvt_pk_bf16_f32 v87, v110, v111
    s_add_u32 s6, s4, 3
    s_and_b32 s6, s6, 7
    s_mul_i32 s6, s6, 4224
    v_add_u32 v3, s6, v4
    ds_write_b128 v3, v[84:87] offset:0
    v_dot2_f32_bf16 v108, v90, s65, v6
    v_dot2_f32_bf16 v109, v90, s66, v6
    v_cvt_pk_bf16_f32 v88, v104, v105
    v_dot2_f32_bf16 v110, v91, s65, v6
    v_dot2_f32_bf16 v111, v91, s66, v6
    v_cvt_pk_bf16_f32 v89, v106, v107
    v_dot2_f32_bf16 v104, v92, s65, v6
    v_dot2_f32_bf16 v105, v92, s66, v6
    v_cvt_pk_bf16_f32 v90, v108, v109
    v_dot2_f32_bf16 v106, v93, s65, v6
    v_dot2_f32_bf16 v107, v93, s66, v6
    v_cvt_pk_bf16_f32 v91, v110, v111
    s_add_u32 s6, s4, 4
    s_and_b32 s6, s6, 7
    s_mul_i32 s6, s6, 4224
    v_add_u32 v3, s6, v4
    ds_write_b128 v3, v[88:91] offset:0
    v_dot2_f32_bf16 v108, v94, s65, v6
    v_dot2_f32_bf16 v109, v94, s66, v6
    v_cvt_pk_bf16_f32 v92, v104, v105
    v_dot2_f32_bf16 v110, v95, s65, v6
    v_dot2_f32_bf16 v111, v95, s66, v6
    v_cvt_pk_bf16_f32 v93, v106, v107
    v_dot2_f32_bf16 v104, v96, s65, v6
    v_dot2_f32_bf16 v105, v96, s66, v6
    v_cvt_pk_bf16_f32 v94, v108, v109
    v_dot2_f32_bf16 v106, v97, s65, v6
    v_dot2_f32_bf16 v107, v97, s66, v6
    v_cvt_pk_bf16_f32 v95, v110, v111
    s_add_u32 s6, s4, 5
    s_and_b32 s6, s6, 7
    s_mul_i32 s6, s6, 4224
    v_add_u32 v3, s6, v4
    ds_write_b128 v3, v[92:95] offset:0
    v_dot2_f32_bf16 v108, v98, s65, v6
    v_dot2_f32_bf16 v109, v98, s66, v6
    v_cvt_pk_bf16_f32 v96, v104, v105
    v_dot2_f32_bf16 v110, v99, s65, v6
    v_dot2_f32_bf16 v111, v99, s66, v6
    v_cvt_pk_bf16_f32 v97, v106, v107
    v_dot2_f32_bf16 v104, v100, s65, v6
    v_dot2_f32_bf16 v105, v100, s66, v6
    v_cvt_pk_bf16_f32 v98, v108, v109
    v_dot2_f32_bf16 v106, v101, s65, v6
    v_dot2_f32_bf16 v107, v101, s66, v6
    v_cvt_pk_bf16_f32 v99, v110, v111
    s_add_u32 s6, s4, 6
    s_and_b32 s6, s6, 7
    s_mul_i32 s6, s6, 4224
    v_add_u32 v3, s6, v4
    ds_write_b128 v3, v[96:99] offset:0
    v_dot2_f32_bf16 v108, v102, s65, v6
    v_dot2_f32_bf16 v109, v102, s66, v6
    v_cvt_pk_bf16_f32 v100, v104, v105
    v_dot2_f32_bf16 v110, v103, s65, v6
    v_dot2_f32_bf16 v111, v103, s66, v6
    v_cvt_pk_bf16_f32 v101, v106, v107
    s_nop 0
    v_cvt_pk_bf16_f32 v102, v108, v109
    v_cvt_pk_bf16_f32 v103, v110, v111
    s_add_u32 s6, s4, 7
    s_and_b32 s6, s6, 7
    s_mul_i32 s6, s6, 4224
    v_add_u32 v3, s6, v4
    ds_write_b128 v3, v[100:103] offset:0
    s_waitcnt lgkmcnt(0)
    s_mov_b64 exec, 1
    ds_add_u32 v166, v165 offset:32
    s_mov_b64 exec, -1
    s_cmp_ge_u32 s3, 4
    s_cbranch_scc1 L_kv
    v_mov_b32 v4, 0x10000
L_spin_8:
    ds_read_b32 v6, v166 offset:32
    s_waitcnt lgkmcnt(0)
    v_readfirstlane_b32 s6, v6
    s_nop 0
    s_bfe_u32 s7, s6, 0x80008
    s_cmp_ge_u32 s7, 11
    s_cbranch_scc1 L_spun_9
    s_sub_u32 s86, s86, 1
    s_cbranch_scc0 L_spin_8
    s_mov_b32 s86, 0
L_spun_9:
    s_setprio 2
L_bspin_10:
    ds_read_b32 v6, v166 offset:32
    ds_read_b64_tr_b16 v[88:89], v156 offset:0
    ds_read_b64_tr_b16 v[90:91], v156 offset:512
    ds_read_b128 v[92:95], v157 offset:0
    ds_read_b64_tr_b16 v[96:97], v156 offset:2048
    ds_read_b64_tr_b16 v[98:99], v156 offset:2560
    ds_read_b128 v[100:103], v157 offset:1056
    ds_read_b64_tr_b16 v[104:105], v156 offset:4096
    ds_read_b64_tr_b16 v[106:107], v156 offset:4608
    ds_read_b128 v[108:111], v157 offset:2112
    ds_read_b32 v7, v158
    ds_read_b32 v5, v166 offset:64
    s_waitcnt lgkmcnt(11)
    v_readfirstlane_b32 s6, v6
    s_nop 0
    s_bfe_u32 s7, s6, 0x80008
    s_cmp_ge_u32 s7, 12
    s_cbranch_scc1 L_bspun_11
    s_waitcnt lgkmcnt(0)
    s_sub_u32 s86, s86, 1
    s_cbranch_scc0 L_bspin_10
    s_mov_b32 s86, 0
L_bspun_11:
    s_waitcnt lgkmcnt(8)
    v_mfma_f32_32x32x16_bf16 v[72:87], v[88:91], v[92:95], 0
    ds_read_b64_tr_b16 v[112:113], v156 offset:6144
    ds_read_b64_tr_b16 v[114:115], v156 offset:6656
    ds_read_b128 v[116:119], v157 offset:3168
    s_waitcnt lgkmcnt(8)
    v_mfma_f32_32x32x16_bf16 v[72:87], v[96:99], v[100:103], v[72:87]
    ds_read_b64_tr_b16 v[88:89], v156 offset:8192
    ds_read_b64_tr_b16 v[90:91], v156 offset:8704
    ds_read_b128 v[92:95], v157 offset:4224
    s_waitcnt lgkmcnt(8)
    v_mfma_f32_32x32x16_bf16 v[72:87], v[104:107], v[108:111], v[72:87]
    ds_read_b64_tr_b16 v[96:97], v156 offset:10240
    ds_read_b64_tr_b16 v[98:99], v156 offset:10752
    ds_read_b128 v[100:103], v157 offset:5280
    s_waitcnt lgkmcnt(6)
    v_mfma_f32_32x32x16_bf16 v[72:87], v[112:115], v[116:119], v[72:87]
    ds_read_b64_tr_b16 v[104:105], v156 offset:12288
    ds_read_b64_tr_b16 v[106:107], v156 offset:12800
    ds_read_b128 v[108:111], v157 offset:6336
    s_waitcnt lgkmcnt(6)
    v_mfma_f32_32x32x16_bf16 v[72:87], v[88:91], v[92:95], v[72:87]
    ds_read_b64_tr_b16 v[112:113], v156 offset:14336
    ds_read_b64_tr_b16 v[114:115], v156 offset:14848
    ds_read_b128 v[116:119], v157 offset:7392
    s_waitcnt lgkmcnt(6)
    v_mfma_f32_32x32x16_bf16 v[72:87], v[96:99], v[100:103], v[72:87]
    ds_read_b64_tr_b16 v[88:89], v156 offset:16384
    ds_read_b64_tr_b16 v[90:91], v156 offset:16896
    ds_read_b128 v[92:95], v157 offset:8448
    s_waitcnt lgkmcnt(6)
    v_mfma_f32_32x32x16_bf16 v[72:87], v[104:107], v[108:111], v[72:87]
    ds_read_b64_tr_b16 v[96:97], v156 offset:18432
    ds_read_b64_tr_b16 v[98:99], v156 offset:18944
    ds_read_b128 v[100:103], v157 offset:9504
    s_waitcnt lgkmcnt(6)
    v_mfma_f32_32x32x16_bf16 v[72:87], v[112:115], v[116:119], v[72:87]
    ds_read_b64_tr_b16 v[104:105], v156 offset:20480
    ds_read_b64_tr_b16 v[106:107], v156 offset:20992
    ds_read_b128 v[108:111], v157 offset:10560
    s_waitcnt lgkmcnt(6)
    v_mfma_f32_32x32x16_bf16 v[72:87], v[88:91], v[92:95], v[72:87]
    ds_read_b64_tr_b16 v[112:113], v156 offset:22528
    ds_read_b64_tr_b16 v[114:115], v156 offset:23040
    ds_read_b128 v[116:119], v157 offset:11616
    v_mul_f32 v7, 0x3eb8aa3b, v7
    v_readfirstlane_b32 s43, v5
    s_waitcnt lgkmcnt(6)
    v_mfma_f32_32x32x16_bf16 v[72:87], v[96:99], v[100:103], v[72:87]
    ds_read_b64_tr_b16 v[88:89], v156 offset:24576
    ds_read_b64_tr_b16 v[90:91], v156 offset:25088
    ds_read_b128 v[92:95], v157 offset:12672
    s_waitcnt lgkmcnt(6)
    v_mfma_f32_32x32x16_bf16 v[72:87], v[104:107], v[108:111], v[72:87]
    ds_read_b64_tr_b16 v[96:97], v156 offset:26624
    ds_read_b64_tr_b16 v[98:99], v156 offset:27136
    ds_read_b128 v[100:103], v157 offset:13728
    s_waitcnt lgkmcnt(6)
    v_mfma_f32_32x32x16_bf16 v[72:87], v[112:115], v[116:119], v[72:87]
    ds_read_b64_tr_b16 v[104:105], v156 offset:28672
    ds_read_b64_tr_b16 v[106:107], v156 offset:29184
    ds_read_b128 v[108:111], v157 offset:14784
    s_waitcnt lgkmcnt(6)
    v_mfma_f32_32x32x16_bf16 v[72:87], v[88:91], v[92:95], v[72:87]
    ds_read_b64_tr_b16 v[112:113], v156 offset:30720
    ds_read_b64_tr_b16 v[114:115], v156 offset:31232
    ds_read_b128 v[116:119], v157 offset:15840
    s_waitcnt lgkmcnt(6)
    v_mfma_f32_32x32x16_bf16 v[72:87], v[96:99], v[100:103], v[72:87]
    ds_read_b64_tr_b16 v[88:89], v156 offset:32768
    ds_read_b64_tr_b16 v[90:91], v156 offset:33280
    ds_read_b128 v[92:95], v157 offset:16896
    s_waitcnt lgkmcnt(6)
    v_mfma_f32_32x32x16_bf16 v[72:87], v[104:107], v[108:111], v[72:87]
    ds_read_b64_tr_b16 v[96:97], v156 offset:34816
    ds_read_b64_tr_b16 v[98:99], v156 offset:35328
    ds_read_b128 v[100:103], v157 offset:17952
    s_waitcnt lgkmcnt(6)
    v_mfma_f32_32x32x16_bf16 v[72:87], v[112:115], v[116:119], v[72:87]
    ds_read_b64_tr_b16 v[104:105], v156 offset:36864
    ds_read_b64_tr_b16 v[106:107], v156 offset:37376
    ds_read_b128 v[108:111], v157 offset:19008
    s_waitcnt lgkmcnt(6)
    v_mfma_f32_32x32x16_bf16 v[72:87], v[88:91], v[92:95], v[72:87]
    ds_read_b64_tr_b16 v[112:113], v156 offset:38912
    ds_read_b64_tr_b16 v[114:115], v156 offset:39424
    ds_read_b128 v[116:119], v157 offset:20064
    s_waitcnt lgkmcnt(6)
    v_mfma_f32_32x32x16_bf16 v[72:87], v[96:99], v[100:103], v[72:87]
    ds_read_b64_tr_b16 v[88:89], v156 offset:40960
    ds_read_b64_tr_b16 v[90:91], v156 offset:41472
    ds_read_b128 v[92:95], v157 offset:21120
    s_waitcnt lgkmcnt(6)
    v_mfma_f32_32x32x16_bf16 v[72:87], v[104:107], v[108:111], v[72:87]
    ds_read_b64_tr_b16 v[96:97], v156 offset:43008
    ds_read_b64_tr_b16 v[98:99], v156 offset:43520
    ds_read_b128 v[100:103], v157 offset:22176
    s_waitcnt lgkmcnt(6)
    v_mfma_f32_32x32x16_bf16 v[72:87], v[112:115], v[116:119], v[72:87]
    ds_read_b64_tr_b16 v[104:105], v156 offset:45056
    ds_read_b64_tr_b16 v[106:107], v156 offset:45568
    ds_read_b128 v[108:111], v157 offset:23232
    s_waitcnt lgkmcnt(6)
    v_mfma_f32_32x32x16_bf16 v[72:87], v[88:91], v[92:95], v[72:87]
    ds_read_b64_tr_b16 v[112:113], v156 offset:47104
    ds_read_b64_tr_b16 v[114:115], v156 offset:47616
    ds_read_b128 v[116:119], v157 offset:24288
    s_waitcnt lgkmcnt(6)
    v_mfma_f32_32x32x16_bf16 v[72:87], v[96:99], v[100:103], v[72:87]
    ds_read_b64_tr_b16 v[88:89], v156 offset:49152
    ds_read_b64_tr_b16 v[90:91], v156 offset:49664
    ds_read_b128 v[92:95], v157 offset:25344
    s_waitcnt lgkmcnt(6)
    v_mfma_f32_32x32x16_bf16 v[72:87], v[104:107], v[108:111], v[72:87]
    ds_read_b64_tr_b16 v[96:97], v156 offset:51200
    ds_read_b64_tr_b16 v[98:99], v156 offset:51712
    ds_read_b128 v[100:103], v157 offset:26400
    s_mov_b64 exec, 1
    ds_add_u32 v166, v4 offset:36
    s_mov_b64 exec, -1
    s_waitcnt lgkmcnt(7)
    v_mfma_f32_32x32x16_bf16 v[72:87], v[112:115], v[116:119], v[72:87]
    ds_read_b64_tr_b16 v[104:105], v156 offset:53248
    ds_read_b64_tr_b16 v[106:107], v156 offset:53760
    ds_read_b128 v[108:111], v157 offset:27456
    s_waitcnt lgkmcnt(7)
    v_mfma_f32_32x32x16_bf16 v[72:87], v[88:91], v[92:95], v[72:87]
    ds_read_b64_tr_b16 v[112:113], v156 offset:55296
    ds_read_b64_tr_b16 v[114:115], v156 offset:55808
    ds_read_b128 v[116:119], v157 offset:28512
    s_waitcnt lgkmcnt(7)
    v_mfma_f32_32x32x16_bf16 v[72:87], v[96:99], v[100:103], v[72:87]
    ds_read_b64_tr_b16 v[88:89], v156 offset:57344
    ds_read_b64_tr_b16 v[90:91], v156 offset:57856
    ds_read_b128 v[92:95], v157 offset:29568
    s_waitcnt lgkmcnt(6)
    v_mfma_f32_32x32x16_bf16 v[72:87], v[104:107], v[108:111], v[72:87]
    ds_read_b64_tr_b16 v[96:97], v156 offset:59392
    ds_read_b64_tr_b16 v[98:99], v156 offset:59904
    ds_read_b128 v[100:103], v157 offset:30624
    s_waitcnt lgkmcnt(6)
    v_mfma_f32_32x32x16_bf16 v[72:87], v[112:115], v[116:119], v[72:87]
    ds_read_b64_tr_b16 v[104:105], v156 offset:61440
    ds_read_b64_tr_b16 v[106:107], v156 offset:61952
    ds_read_b128 v[108:111], v157 offset:31680
    s_waitcnt lgkmcnt(6)
    v_mfma_f32_32x32x16_bf16 v[72:87], v[88:91], v[92:95], v[72:87]
    ds_read_b64_tr_b16 v[112:113], v156 offset:63488
    ds_read_b64_tr_b16 v[114:115], v156 offset:64000
    ds_read_b128 v[116:119], v157 offset:32736
    s_waitcnt lgkmcnt(6)
    v_mfma_f32_32x32x16_bf16 v[72:87], v[96:99], v[100:103], v[72:87]
    s_waitcnt lgkmcnt(3)
    v_mfma_f32_32x32x16_bf16 v[72:87], v[104:107], v[108:111], v[72:87]
    s_waitcnt lgkmcnt(0)
    v_mfma_f32_32x32x16_bf16 v[72:87], v[112:115], v[116:119], v[72:87]
    v_mov_b32 v5, 0x101
    s_lshl_b32 s8, s10, 2
    v_add_u32 v3, s8, v166
    s_nop 8
    v_pk_mul_f32 v[72:73], v[72:73], v[6:7] op_sel:[0,1] op_sel_hi:[1,1]
    v_pk_mul_f32 v[74:75], v[74:75], v[6:7] op_sel:[0,1] op_sel_hi:[1,1]
    v_pk_mul_f32 v[76:77], v[76:77], v[6:7] op_sel:[0,1] op_sel_hi:[1,1]
    v_pk_mul_f32 v[78:79], v[78:79], v[6:7] op_sel:[0,1] op_sel_hi:[1,1]
    v_pk_mul_f32 v[80:81], v[80:81], v[6:7] op_sel:[0,1] op_sel_hi:[1,1]
    v_pk_mul_f32 v[82:83], v[82:83], v[6:7] op_sel:[0,1] op_sel_hi:[1,1]
    v_pk_mul_f32 v[84:85], v[84:85], v[6:7] op_sel:[0,1] op_sel_hi:[1,1]
    v_pk_mul_f32 v[86:87], v[86:87], v[6:7] op_sel:[0,1] op_sel_hi:[1,1]
    v_cvt_pk_bf16_f32 v88, v72, v73
    v_cvt_pk_bf16_f32 v89, v74, v75
    v_cvt_pk_bf16_f32 v90, v76, v77
    v_cvt_pk_bf16_f32 v91, v78, v79
    ds_write_b128 v159, v[88:91]
    v_cvt_pk_bf16_f32 v92, v80, v81
    v_cvt_pk_bf16_f32 v93, v82, v83
    v_cvt_pk_bf16_f32 v94, v84, v85
    v_cvt_pk_bf16_f32 v95, v86, v87
    ds_write_b128 v159, v[92:95] offset:1024
    s_waitcnt lgkmcnt(0)
    s_mov_b64 exec, 1
    ds_add_u32 v166, v5 offset:36
    s_mov_b64 exec, -1
    v_mov_b32 v161, 0xdddd
    s_mov_b32 s72, 0x0000ffff
    s_mov_b32 s73, 0x0000ffff
    s_mov_b32 s74, 0x00110000
    s_mov_b32 s75, 0x00110000
    v_mov_b32 v6, 0
    v_mov_b32 v7, 0x3f803f80
    v_cndmask_b32 v6, v6, v7, s[74:75]
    s_mul_i32 s80, s10, 1024
    s_add_u32 s80, s80, 13631488
    s_mov_b32 s77, 0
    s_cmp_eq_u32 s11, 0
    s_cselect_b32 s71, 2, 0
    s_lshr_b32 s12, s2, 4
    s_and_b32 s12, s12, 0
    s_lshl_b32 s12, s12, 11
    s_lshl_b32 s9, s11, 2
    v_add_u32 v164, s9, v166
    v_mov_b32 v120, 0
    v_mov_b32 v121, 0
    v_mov_b32 v122, 0
    v_mov_b32 v123, 0
    v_mov_b32 v124, v6
    v_mov_b32 v125, v6
    v_mov_b32 v126, v6
    v_mov_b32 v127, v6
    v_mov_b32 v128, v6
    v_mov_b32 v129, v6
    v_mov_b32 v130, v6
    v_mov_b32 v131, v6
    v_mov_b32 v136, v6
    v_mov_b32 v137, v6
    v_mov_b32 v138, v6
    v_mov_b32 v139, v6
    v_mov_b32 v140, v6
    v_mov_b32 v141, v6
    v_mov_b32 v142, v6
    v_mov_b32 v143, v6
    v_mfma_f32_32x32x16_bf16 v[8:23], v[120:123], v[120:123], 0
    s_add_u32 s6, s10, 1
    s_and_b32 s6, s6, 3
    s_add_u32 s6, s6, s9
    s_lshl_b32 s7, s6, 10
    s_add_u32 s88, s7, 149760
    s_xor_b32 s6, s6, 4
    s_mul_i32 s92, s6, 6912
    v_mfma_f32_32x32x16_bf16 v[24:39], v[120:123], v[120:123], 0
    s_add_u32 s6, s10, 2
    s_and_b32 s6, s6, 3
    s_add_u32 s6, s6, s9
    s_lshl_b32 s7, s6, 10
    s_add_u32 s89, s7, 149760
    s_xor_b32 s6, s6, 4
    s_mul_i32 s93, s6, 6912
    v_mfma_f32_32x32x16_bf16 v[40:55], v[120:123], v[120:123], 0
    s_add_u32 s6, s10, 3
    s_and_b32 s6, s6, 3
    s_add_u32 s6, s6, s9
    s_lshl_b32 s7, s6, 10
    s_add_u32 s90, s7, 149760
    s_xor_b32 s6, s6, 4
    s_mul_i32 s94, s6, 6912
    v_mfma_f32_32x32x16_bf16 v[56:71], v[120:123], v[120:123], 0
    s_add_u32 s6, s10, 4
    s_and_b32 s6, s6, 3
    s_add_u32 s6, s6, s9
    s_lshl_b32 s7, s6, 10
    s_add_u32 s91, s7, 149760
    s_xor_b32 s6, s6, 4
    s_mul_i32 s95, s6, 6912
L_spin_12:
    ds_read_b32 v6, v3 offset:40
    s_waitcnt lgkmcnt(0)
    v_readfirstlane_b32 s6, v6
    s_nop 0
    s_bfe_u32 s7, s6, 0x80000
    s_cmp_ge_u32 s7, 1
    s_cbranch_scc1 L_spun_13
    s_sub_u32 s86, s86, 1
    s_cbranch_scc0 L_spin_12
    s_mov_b32 s86, 0
L_spun_13:
    s_lshl_b32 s8, s10, 15
    v_add_u32 v157, s8, v162
    v_add_u32 v163, s8, v163
    buffer_load_dwordx4 v[120:123], v157, s[48:51], s12 offen offset:0 sc1
    s_mov_b64 exec, s[72:73]
    buffer_load_dwordx4 v[124:127], v163, s[48:51], s12 offen offset:1024 sc1
    s_mov_b64 exec, -1
    s_mov_b64 exec, s[72:73]
    buffer_load_dwordx4 v[128:131], v163, s[48:51], s12 offen offset:1536 sc1
    s_mov_b64 exec, -1
    s_add_u32 s12, s12, 2048
    s_and_b32 s12, s12, 0x7fff
    buffer_load_dwordx4 v[132:135], v157, s[48:51], s12 offen offset:0 sc1
    s_mov_b64 exec, s[72:73]
    buffer_load_dwordx4 v[136:139], v163, s[48:51], s12 offen offset:1024 sc1
    s_mov_b64 exec, -1
    s_mov_b32 s76, s6
    s_setprio 2
    s_branch L_b2
L_kv:
    s_cmp_lg_u32 s3, 4
    s_cbranch_scc1 L_nokv_14
    s_bitcmp1_b32 s4, 0
    s_cbranch_scc1 L_kvV_17
L_bspin_19:
    ds_read_b32 v6, v166 offset:32
    ds_read_b64_tr_b16 v[88:89], v156 offset:0
    ds_read_b64_tr_b16 v[90:91], v156 offset:128
    ds_read_b128 v[92:95], v157 offset:0
    ds_read_b64_tr_b16 v[96:97], v156 offset:1024
    ds_read_b64_tr_b16 v[98:99], v156 offset:1152
    ds_read_b128 v[100:103], v157 offset:2112
    ds_read_b64_tr_b16 v[104:105], v156 offset:2048
    ds_read_b64_tr_b16 v[106:107], v156 offset:2176
    ds_read_b128 v[108:111], v157 offset:4224
    ds_read_b64_tr_b16 v[112:113], v156 offset:3072
    ds_read_b64_tr_b16 v[114:115], v156 offset:3200
    ds_read_b128 v[116:119], v157 offset:6336
    ds_read_b32 v76, v158
    ds_read_b32 v5, v166 offset:64
    s_waitcnt lgkmcnt(14)
    v_readfirstlane_b32 s6, v6
    s_nop 0
    s_bfe_u32 s7, s6, 0x80000
    s_cmp_ge_u32 s7, 4
    s_cbranch_scc1 L_bspun_20
    s_waitcnt lgkmcnt(0)
    s_sub_u32 s86, s86, 1
    s_cbranch_scc0 L_bspin_19
    s_mov_b32 s86, 0
L_bspun_20:
    s_waitcnt lgkmcnt(11)
    v_mfma_f32_16x16x32_bf16 v[72:75], v[88:91], v[92:95], 0
    ds_read_b64_tr_b16 v[88:89], v156 offset:4096
    ds_read_b64_tr_b16 v[90:91], v156 offset:4224
    ds_read_b128 v[92:95], v157 offset:8448
    s_waitcnt lgkmcnt(11)
    v_mfma_f32_16x16x32_bf16 v[72:75], v[96:99], v[100:103], v[72:75]
    ds_read_b64_tr_b16 v[96:97], v156 offset:5120
    ds_read_b64_tr_b16 v[98:99], v156 offset:5248
    ds_read_b128 v[100:103], v157 offset:10560
    s_waitcnt lgkmcnt(11)
    v_mfma_f32_16x16x32_bf16 v[72:75], v[104:107], v[108:111], v[72:75]
    ds_read_b64_tr_b16 v[104:105], v156 offset:6144
    ds_read_b64_tr_b16 v[106:107], v156 offset:6272
    ds_read_b128 v[108:111], v157 offset:12672
    s_waitcnt lgkmcnt(11)
    v_mfma_f32_16x16x32_bf16 v[72:75], v[112:115], v[116:119], v[72:75]
    ds_read_b64_tr_b16 v[112:113], v156 offset:7168
    ds_read_b64_tr_b16 v[114:115], v156 offset:7296
    ds_read_b128 v[116:119], v157 offset:14784
    s_waitcnt lgkmcnt(9)
    v_mfma_f32_16x16x32_bf16 v[72:75], v[88:91], v[92:95], v[72:75]
    ds_read_b64_tr_b16 v[88:89], v156 offset:8192
    ds_read_b64_tr_b16 v[90:91], v156 offset:8320
    ds_read_b128 v[92:95], v157 offset:16896
    s_waitcnt lgkmcnt(9)
    v_mfma_f32_16x16x32_bf16 v[72:75], v[96:99], v[100:103], v[72:75]
    ds_read_b64_tr_b16 v[96:97], v156 offset:9216
    ds_read_b64_tr_b16 v[98:99], v156 offset:9344
    ds_read_b128 v[100:103], v157 offset:19008
    s_waitcnt lgkmcnt(9)
    v_mfma_f32_16x16x32_bf16 v[72:75], v[104:107], v[108:111], v[72:75]
    ds_read_b64_tr_b16 v[104:105], v156 offset:10240
    ds_read_b64_tr_b16 v[106:107], v156 offset:10368
    ds_read_b128 v[108:111], v157 offset:21120
    s_waitcnt lgkmcnt(9)
    v_mfma_f32_16x16x32_bf16 v[72:75], v[112:115], v[116:119], v[72:75]
    ds_read_b64_tr_b16 v[112:113], v156 offset:11264
    ds_read_b64_tr_b16 v[114:115], v156 offset:11392
    ds_read_b128 v[116:119], v157 offset:23232
    s_waitcnt lgkmcnt(9)
    v_mfma_f32_16x16x32_bf16 v[72:75], v[88:91], v[92:95], v[72:75]
    ds_read_b64_tr_b16 v[88:89], v156 offset:12288
    ds_read_b64_tr_b16 v[90:91], v156 offset:12416
    ds_read_b128 v[92:95], v157 offset:25344
    s_waitcnt lgkmcnt(9)
    v_mfma_f32_16x16x32_bf16 v[72:75], v[96:99], v[100:103], v[72:75]
    ds_read_b64_tr_b16 v[96:97], v156 offset:13312
    ds_read_b64_tr_b16 v[98:99], v156 offset:13440
    ds_read_b128 v[100:103], v157 offset:27456
    s_waitcnt lgkmcnt(9)
    v_mfma_f32_16x16x32_bf16 v[72:75], v[104:107], v[108:111], v[72:75]
    ds_read_b64_tr_b16 v[104:105], v156 offset:14336
    ds_read_b64_tr_b16 v[106:107], v156 offset:14464
    ds_read_b128 v[108:111], v157 offset:29568
    s_waitcnt lgkmcnt(9)
    v_mfma_f32_16x16x32_bf16 v[72:75], v[112:115], v[116:119], v[72:75]
    ds_read_b64_tr_b16 v[112:113], v156 offset:15360
    ds_read_b64_tr_b16 v[114:115], v156 offset:15488
    ds_read_b128 v[116:119], v157 offset:31680
    s_waitcnt lgkmcnt(9)
    v_mfma_f32_16x16x32_bf16 v[72:75], v[88:91], v[92:95], v[72:75]
    s_waitcnt lgkmcnt(6)
    v_mfma_f32_16x16x32_bf16 v[72:75], v[96:99], v[100:103], v[72:75]
    s_waitcnt lgkmcnt(3)
    v_mfma_f32_16x16x32_bf16 v[72:75], v[104:107], v[108:111], v[72:75]
    s_waitcnt lgkmcnt(0)
    v_mfma_f32_16x16x32_bf16 v[72:75], v[112:115], v[116:119], v[72:75]
    v_readfirstlane_b32 s43, v5
    s_nop 6
    v_pk_mul_f32 v[72:73], v[72:73], v[76:77] op_sel_hi:[1,0]
    v_pk_mul_f32 v[74:75], v[74:75], v[76:77] op_sel_hi:[1,0]
    s_branch L_kvE_18
L_kvV_17:
L_bspin_21:
    ds_read_b32 v6, v166 offset:32
    ds_read_b64_tr_b16 v[88:89], v156 offset:0
    ds_read_b64_tr_b16 v[90:91], v156 offset:128
    ds_read_b128 v[92:95], v157 offset:0
    ds_read_b64_tr_b16 v[96:97], v156 offset:1024
    ds_read_b64_tr_b16 v[98:99], v156 offset:1152
    ds_read_b128 v[100:103], v157 offset:2112
    ds_read_b64_tr_b16 v[104:105], v156 offset:2048
    ds_read_b64_tr_b16 v[106:107], v156 offset:2176
    ds_read_b128 v[108:111], v157 offset:4224
    ds_read_b64_tr_b16 v[112:113], v156 offset:3072
    ds_read_b64_tr_b16 v[114:115], v156 offset:3200
    ds_read_b128 v[116:119], v157 offset:6336
    ds_read_b128 v[76:79], v158
    ds_read_b32 v5, v166 offset:64
    s_waitcnt lgkmcnt(14)
    v_readfirstlane_b32 s6, v6
    s_nop 0
    s_bfe_u32 s7, s6, 0x80000
    s_cmp_ge_u32 s7, 4
    s_cbranch_scc1 L_bspun_22
    s_waitcnt lgkmcnt(0)
    s_sub_u32 s86, s86, 1
    s_cbranch_scc0 L_bspin_21
    s_mov_b32 s86, 0
L_bspun_22:
    s_waitcnt lgkmcnt(11)
    v_mfma_f32_16x16x32_bf16 v[72:75], v[92:95], v[88:91], 0
    ds_read_b64_tr_b16 v[88:89], v156 offset:4096
    ds_read_b64_tr_b16 v[90:91], v156 offset:4224
    ds_read_b128 v[92:95], v157 offset:8448
    s_waitcnt lgkmcnt(11)
    v_mfma_f32_16x16x32_bf16 v[72:75], v[100:103], v[96:99], v[72:75]
    ds_read_b64_tr_b16 v[96:97], v156 offset:5120
    ds_read_b64_tr_b16 v[98:99], v156 offset:5248
    ds_read_b128 v[100:103], v157 offset:10560
    s_waitcnt lgkmcnt(11)
    v_mfma_f32_16x16x32_bf16 v[72:75], v[108:111], v[104:107], v[72:75]
    ds_read_b64_tr_b16 v[104:105], v156 offset:6144
    ds_read_b64_tr_b16 v[106:107], v156 offset:6272
    ds_read_b128 v[108:111], v157 offset:12672
    s_waitcnt lgkmcnt(11)
    v_mfma_f32_16x16x32_bf16 v[72:75], v[116:119], v[112:115], v[72:75]
    ds_read_b64_tr_b16 v[112:113], v156 offset:7168
    ds_read_b64_tr_b16 v[114:115], v156 offset:7296
    ds_read_b128 v[116:119], v157 offset:14784
    s_waitcnt lgkmcnt(9)
    v_mfma_f32_16x16x32_bf16 v[72:75], v[92:95], v[88:91], v[72:75]
    ds_read_b64_tr_b16 v[88:89], v156 offset:8192
    ds_read_b64_tr_b16 v[90:91], v156 offset:8320
    ds_read_b128 v[92:95], v157 offset:16896
    s_waitcnt lgkmcnt(9)
    v_mfma_f32_16x16x32_bf16 v[72:75], v[100:103], v[96:99], v[72:75]
    ds_read_b64_tr_b16 v[96:97], v156 offset:9216
    ds_read_b64_tr_b16 v[98:99], v156 offset:9344
    ds_read_b128 v[100:103], v157 offset:19008
    s_waitcnt lgkmcnt(9)
    v_mfma_f32_16x16x32_bf16 v[72:75], v[108:111], v[104:107], v[72:75]
    ds_read_b64_tr_b16 v[104:105], v156 offset:10240
    ds_read_b64_tr_b16 v[106:107], v156 offset:10368
    ds_read_b128 v[108:111], v157 offset:21120
    s_waitcnt lgkmcnt(9)
    v_mfma_f32_16x16x32_bf16 v[72:75], v[116:119], v[112:115], v[72:75]
    ds_read_b64_tr_b16 v[112:113], v156 offset:11264
    ds_read_b64_tr_b16 v[114:115], v156 offset:11392
    ds_read_b128 v[116:119], v157 offset:23232
    s_waitcnt lgkmcnt(9)
    v_mfma_f32_16x16x32_bf16 v[72:75], v[92:95], v[88:91], v[72:75]
    ds_read_b64_tr_b16 v[88:89], v156 offset:12288
    ds_read_b64_tr_b16 v[90:91], v156 offset:12416
    ds_read_b128 v[92:95], v157 offset:25344
    s_waitcnt lgkmcnt(9)
    v_mfma_f32_16x16x32_bf16 v[72:75], v[100:103], v[96:99], v[72:75]
    ds_read_b64_tr_b16 v[96:97], v156 offset:13312
    ds_read_b64_tr_b16 v[98:99], v156 offset:13440
    ds_read_b128 v[100:103], v157 offset:27456
    s_waitcnt lgkmcnt(9)
    v_mfma_f32_16x16x32_bf16 v[72:75], v[108:111], v[104:107], v[72:75]
    ds_read_b64_tr_b16 v[104:105], v156 offset:14336
    ds_read_b64_tr_b16 v[106:107], v156 offset:14464
    ds_read_b128 v[108:111], v157 offset:29568
    s_waitcnt lgkmcnt(9)
    v_mfma_f32_16x16x32_bf16 v[72:75], v[116:119], v[112:115], v[72:75]
    ds_read_b64_tr_b16 v[112:113], v156 offset:15360
    ds_read_b64_tr_b16 v[114:115], v156 offset:15488
    ds_read_b128 v[116:119], v157 offset:31680
    s_waitcnt lgkmcnt(9)
    v_mfma_f32_16x16x32_bf16 v[72:75], v[92:95], v[88:91], v[72:75]
    s_waitcnt lgkmcnt(6)
    v_mfma_f32_16x16x32_bf16 v[72:75], v[100:103], v[96:99], v[72:75]
    s_waitcnt lgkmcnt(3)
    v_mfma_f32_16x16x32_bf16 v[72:75], v[108:111], v[104:107], v[72:75]
    s_waitcnt lgkmcnt(0)
    v_mfma_f32_16x16x32_bf16 v[72:75], v[116:119], v[112:115], v[72:75]
    v_readfirstlane_b32 s43, v5
    s_nop 6
    v_pk_mul_f32 v[72:73], v[72:73], v[76:77]
    v_pk_mul_f32 v[74:75], v[74:75], v[78:79]
L_kvE_18:
    v_cvt_pk_bf16_f32 v88, v72, v73
    v_cvt_pk_bf16_f32 v89, v74, v75
    buffer_store_dwordx2 v[88:89], v159, s[48:51], s78 offen offset:0 sc1
    v_mov_b32 v7, 0x100
    s_mov_b64 exec, 1
    ds_add_u32 v166, v7 offset:36
    s_mov_b64 exec, -1
    v_max3_f32 v6, abs(v72), abs(v73), abs(v74)
    v_max_f32 v6, abs(v75), v6
    v_cmp_le_f32 vcc, 0x5d800000, v6
    s_mul_i32 s7, s42, 16
    s_add_u32 s7, s7, 13631488
    s_cmp_lg_u64 vcc, 0
    s_cselect_b32 s6, 0x80000000, 0
    s_xor_b32 s6, s6, s43
    v_mov_b32 v6, s6
    s_getreg_b32 s6, hwreg(HW_REG_XCC_ID, 0, 4)
    s_xor_b32 s6, s6, s43
    v_mov_b32 v7, s6
    s_waitcnt vmcnt(0)
    s_mov_b64 exec, 1
    buffer_store_dwordx2 v[6:7], off, s[48:51], s7 sc1
    s_mov_b64 exec, -1
    s_branch L_aset_15
L_nokv_14:
L_aset_15:
    s_setprio 0
    v_mov_b32 v161, 0xdddd
    s_mov_b32 s72, 0x0000ffff
    s_mov_b32 s73, 0x0000ffff
    s_mov_b32 s74, 0x00110000
    s_mov_b32 s75, 0x00110000
    v_mov_b32 v6, 0
    v_mov_b32 v7, 0x3f803f80
    v_cndmask_b32 v6, v6, v7, s[74:75]
    s_mul_i32 s80, s10, 1024
    s_add_u32 s80, s80, 13631488
    s_mov_b32 s77, 0
    s_cmp_eq_u32 s11, 0
    s_cselect_b32 s71, 2, 0
    s_lshr_b32 s12, s2, 4
    s_and_b32 s12, s12, 0
    s_lshl_b32 s12, s12, 11
    s_lshl_b32 s9, s11, 2
    v_add_u32 v164, s9, v166
    v_mov_b32 v120, 0
    v_mov_b32 v121, 0
    v_mov_b32 v122, 0
    v_mov_b32 v123, 0
    v_mov_b32 v124, v6
    v_mov_b32 v125, v6
    v_mov_b32 v126, v6
    v_mov_b32 v127, v6
    v_mov_b32 v128, v6
    v_mov_b32 v129, v6
    v_mov_b32 v130, v6
    v_mov_b32 v131, v6
    v_mov_b32 v136, v6
    v_mov_b32 v137, v6
    v_mov_b32 v138, v6
    v_mov_b32 v139, v6
    v_mov_b32 v140, v6
    v_mov_b32 v141, v6
    v_mov_b32 v142, v6
    v_mov_b32 v143, v6
    v_mfma_f32_32x32x16_bf16 v[8:23], v[120:123], v[120:123], 0
    s_add_u32 s6, s10, 1
    s_and_b32 s6, s6, 3
    s_add_u32 s6, s6, s9
    s_lshl_b32 s7, s6, 10
    s_add_u32 s88, s7, 149760
    s_xor_b32 s6, s6, 4
    s_mul_i32 s92, s6, 6912
    v_mfma_f32_32x32x16_bf16 v[24:39], v[120:123], v[120:123], 0
    s_add_u32 s6, s10, 2
    s_and_b32 s6, s6, 3
    s_add_u32 s6, s6, s9
    s_lshl_b32 s7, s6, 10
    s_add_u32 s89, s7, 149760
    s_xor_b32 s6, s6, 4
    s_mul_i32 s93, s6, 6912
    v_mfma_f32_32x32x16_bf16 v[40:55], v[120:123], v[120:123], 0
    s_add_u32 s6, s10, 3
    s_and_b32 s6, s6, 3
    s_add_u32 s6, s6, s9
    s_lshl_b32 s7, s6, 10
    s_add_u32 s90, s7, 149760
    s_xor_b32 s6, s6, 4
    s_mul_i32 s94, s6, 6912
    v_mfma_f32_32x32x16_bf16 v[56:71], v[120:123], v[120:123], 0
    s_add_u32 s6, s10, 4
    s_and_b32 s6, s6, 3
    s_add_u32 s6, s6, s9
    s_lshl_b32 s7, s6, 10
    s_add_u32 s91, s7, 149760
    s_xor_b32 s6, s6, 4
    s_mul_i32 s95, s6, 6912
L_apoll_16:
    s_lshl_b32 s8, s10, 2
    v_add_u32 v3, s8, v166
L_spin_25:
    ds_read_b32 v6, v166 offset:36
    s_waitcnt lgkmcnt(0)
    v_readfirstlane_b32 s6, v6
    s_nop 0
    s_bfe_u32 s7, s6, 0x80010
    s_cmp_ge_u32 s7, 4
    s_cbranch_scc1 L_spun_26
    s_sleep 1
    s_sub_u32 s86, s86, 1
    s_cbranch_scc0 L_spin_25
    s_mov_b32 s86, 0
L_spun_26:
    s_setprio 3
    ds_read_b32 v7, v166 offset:64
    s_waitcnt lgkmcnt(0)
    v_readfirstlane_b32 s43, v7
    s_nop 1
L_kvpoll_23:
    buffer_load_dwordx2 v[6:7], v160, s[48:51], s80 offen sc1
    s_waitcnt vmcnt(0)
    v_xor_b32 v6, s43, v6
    v_xor_b32 v7, s43, v7
    v_lshlrev_b32 v4, 1, v6
    v_lshrrev_b32 v5, 4, v7
    v_or_b32 v4, v4, v5
    v_cmp_ne_u32 vcc, 0, v4
    s_cbranch_vccz L_kvok_24
    s_sleep 1
    s_sub_u32 s86, s86, 1
    s_cbranch_scc0 L_kvpoll_23
    s_mov_b32 s86, 0
L_kvok_24:
    s_lshr_b32 s6, s5, 3
    s_cmp_lg_u32 s6, s10
    s_cbranch_scc1 L_notmine_27
    s_getreg_b32 s6, hwreg(HW_REG_XCC_ID, 0, 4)
    v_cmp_ne_u32 vcc, s6, v7
    s_and_b32 s6, s5, 7
    s_lshl_b32 s6, s6, 3
    s_lshr_b64 vcc, vcc, s6
    s_and_b32 s6, vcc_lo, 0xff
    s_cselect_b32 s6, 0, 1
    v_mov_b32 v4, s6
    ds_write_b32 v166, v4 offset:68
L_notmine_27:
    v_cmp_ne_u32 vcc, 0, v6
    s_nop 0
    s_cmp_lg_u64 vcc, 0
    s_cselect_b32 s76, 0x101, 1
    v_mov_b32 v6, s76
    ds_write_b32 v3, v6 offset:40
    s_setprio 1
    s_lshl_b32 s8, s10, 15
    v_add_u32 v157, s8, v162
    v_add_u32 v163, s8, v163
    buffer_load_dwordx4 v[120:123], v157, s[48:51], s12 offen offset:0 sc1
    s_mov_b64 exec, s[72:73]
    buffer_load_dwordx4 v[124:127], v163, s[48:51], s12 offen offset:1024 sc1
    s_mov_b64 exec, -1
    s_mov_b64 exec, s[72:73]
    buffer_load_dwordx4 v[128:131], v163, s[48:51], s12 offen offset:1536 sc1
    s_mov_b64 exec, -1
    s_add_u32 s12, s12, 2048
    s_and_b32 s12, s12, 0x7fff
    buffer_load_dwordx4 v[132:135], v157, s[48:51], s12 offen offset:0 sc1
    s_mov_b64 exec, s[72:73]
    buffer_load_dwordx4 v[136:139], v163, s[48:51], s12 offen offset:1024 sc1
    s_mov_b64 exec, -1
L_b2:
    v_add_u32 v72, s88, v162
    v_add_u32 v73, s89, v162
    v_add_u32 v74, s90, v162
    v_add_u32 v75, s91, v162
    v_mov_b32 v96, 0
    v_mov_b32 v97, 0
    v_mov_b32 v98, 0
    v_mov_b32 v99, 0
    v_mov_b32 v100, 0
    v_mov_b32 v101, 0
    v_mov_b32 v102, 0
    v_mov_b32 v103, 0
L_bspin_28:
    ds_read_b32 v6, v166 offset:36
    ds_read_b128 v[104:107], v72
    ds_read_b128 v[108:111], v73
    ds_read_b128 v[112:115], v74
    ds_read_b128 v[116:119], v75
    s_waitcnt lgkmcnt(4)
    v_readfirstlane_b32 s6, v6
    s_nop 0
    s_bfe_u32 s7, s6, 0x80000
    s_cmp_ge_u32 s7, 4
    s_cbranch_scc1 L_bspun_29
    s_waitcnt lgkmcnt(0)
    s_sub_u32 s86, s86, 1
    s_cbranch_scc0 L_bspin_28
    s_mov_b32 s86, 0
L_bspun_29:
    s_mov_b32 s15, 7
    s_waitcnt vmcnt(4) lgkmcnt(0)
    v_mfma_f32_32x32x16_bf16 v[72:87], v[120:123], v[104:107], 0
    s_lshl_b32 s6, s11, 3
    s_lshl_b32 s6, 1, s6
    v_mov_b32 v6, s6
    s_mov_b64 exec, 1
    ds_add_u32 v166, v6 offset:56
    s_mov_b64 exec, -1
    s_nop 5
.p2align 6
L_attn_30:
    v_exp_f32 v72, v72
    v_exp_f32 v73, v73
    v_smfmac_f32_32x32x32_bf16 v[56:71], v[140:143], v[96:103], v161
    s_mov_b64 exec, s[72:73]
    buffer_load_dwordx4 v[140:143], v163, s[48:51], s12 offen offset:1536 sc1
    s_mov_b64 exec, -1
    v_exp_f32 v74, v74
    v_exp_f32 v75, v75
    v_exp_f32 v76, v76
    v_mfma_f32_32x32x16_bf16 v[88:103], v[120:123], v[108:111], 0
    s_waitcnt vmcnt(4)
    v_exp_f32 v77, v77
    v_exp_f32 v78, v78
    v_exp_f32 v79, v79
    v_exp_f32 v80, v80
    v_exp_f32 v81, v81
    v_exp_f32 v82, v82
    v_smfmac_f32_32x32x32_bf16 v[8:23], v[124:127], v[72:79], v161
    s_waitcnt vmcnt(3)
    v_exp_f32 v83, v83
    v_exp_f32 v84, v84
    v_exp_f32 v85, v85
    v_exp_f32 v86, v86
    v_exp_f32 v87, v87
    v_exp_f32 v88, v88
    v_exp_f32 v89, v89
    v_smfmac_f32_32x32x32_bf16 v[8:23], v[128:131], v[80:87], v161
    v_exp_f32 v90, v90
    v_exp_f32 v91, v91
    v_exp_f32 v92, v92
    v_mfma_f32_32x32x16_bf16 v[72:87], v[120:123], v[112:115], 0
    v_exp_f32 v93, v93
    v_exp_f32 v94, v94
    v_exp_f32 v95, v95
    v_exp_f32 v96, v96
    v_exp_f32 v97, v97
    v_exp_f32 v98, v98
    v_smfmac_f32_32x32x32_bf16 v[24:39], v[124:127], v[88:95], v161
    v_exp_f32 v99, v99
    v_exp_f32 v100, v100
    v_exp_f32 v101, v101
    v_exp_f32 v102, v102
    v_exp_f32 v103, v103
    v_exp_f32 v72, v72
    v_exp_f32 v73, v73
    v_smfmac_f32_32x32x32_bf16 v[24:39], v[128:131], v[96:103], v161
    v_exp_f32 v74, v74
    v_exp_f32 v75, v75
    v_exp_f32 v76, v76
    v_mfma_f32_32x32x16_bf16 v[88:103], v[120:123], v[116:119], 0
    s_add_u32 s12, s12, 2048
    s_and_b32 s12, s12, 0x7fff
    buffer_load_dwordx4 v[120:123], v157, s[48:51], s12 offen offset:0 sc1
    v_exp_f32 v77, v77
    v_exp_f32 v78, v78
    v_exp_f32 v79, v79
    v_exp_f32 v80, v80
    v_exp_f32 v81, v81
    v_exp_f32 v82, v82
    v_smfmac_f32_32x32x32_bf16 v[40:55], v[124:127], v[72:79], v161
    v_exp_f32 v83, v83
    v_exp_f32 v84, v84
    v_exp_f32 v85, v85
    v_exp_f32 v86, v86
    v_exp_f32 v87, v87
    v_exp_f32 v88, v88
    v_exp_f32 v89, v89
    v_smfmac_f32_32x32x32_bf16 v[40:55], v[128:131], v[80:87], v161
    s_waitcnt vmcnt(3)
    v_exp_f32 v90, v90
    v_exp_f32 v91, v91
    v_exp_f32 v92, v92
    v_mfma_f32_32x32x16_bf16 v[72:87], v[132:135], v[104:107], 0
    v_exp_f32 v93, v93
    v_exp_f32 v94, v94
    v_exp_f32 v95, v95
    v_exp_f32 v96, v96
    v_exp_f32 v97, v97
    v_exp_f32 v98, v98
    v_smfmac_f32_32x32x32_bf16 v[56:71], v[124:127], v[88:95], v161
    s_mov_b64 exec, s[72:73]
    buffer_load_dwordx4 v[124:127], v163, s[48:51], s12 offen offset:1024 sc1
    s_mov_b64 exec, -1
    v_exp_f32 v99, v99
    v_exp_f32 v100, v100
    v_exp_f32 v101, v101
    v_exp_f32 v102, v102
    v_exp_f32 v103, v103
    v_exp_f32 v72, v72
    v_exp_f32 v73, v73
    v_smfmac_f32_32x32x32_bf16 v[56:71], v[128:131], v[96:103], v161
    s_mov_b64 exec, s[72:73]
    buffer_load_dwordx4 v[128:131], v163, s[48:51], s12 offen offset:1536 sc1
    s_mov_b64 exec, -1
    v_exp_f32 v74, v74
    v_exp_f32 v75, v75
    v_exp_f32 v76, v76
    v_mfma_f32_32x32x16_bf16 v[88:103], v[132:135], v[108:111], 0
    s_waitcnt vmcnt(4)
    v_exp_f32 v77, v77
    v_exp_f32 v78, v78
    v_exp_f32 v79, v79
    v_exp_f32 v80, v80
    v_exp_f32 v81, v81
    v_exp_f32 v82, v82
    v_smfmac_f32_32x32x32_bf16 v[8:23], v[136:139], v[72:79], v161
    s_waitcnt vmcnt(3)
    s_cmp_eq_u32 s15, s71
    s_cbranch_scc0 L_nofl_31
    s_setprio 0
L_nofl_31:
    v_exp_f32 v83, v83
    v_exp_f32 v84, v84
    v_exp_f32 v85, v85
    v_exp_f32 v86, v86
    v_exp_f32 v87, v87
    v_exp_f32 v88, v88
    v_exp_f32 v89, v89
    v_smfmac_f32_32x32x32_bf16 v[8:23], v[140:143], v[80:87], v161
    v_exp_f32 v90, v90
    v_exp_f32 v91, v91
    v_exp_f32 v92, v92
    v_mfma_f32_32x32x16_bf16 v[72:87], v[132:135], v[112:115], 0
    v_exp_f32 v93, v93
    v_exp_f32 v94, v94
    v_exp_f32 v95, v95
    v_exp_f32 v96, v96
    v_exp_f32 v97, v97
    v_exp_f32 v98, v98
    v_smfmac_f32_32x32x32_bf16 v[24:39], v[136:139], v[88:95], v161
    s_sub_u32 s15, s15, 1
    v_exp_f32 v99, v99
    v_exp_f32 v100, v100
    v_exp_f32 v101, v101
    v_exp_f32 v102, v102
    v_exp_f32 v103, v103
    v_exp_f32 v72, v72
    v_exp_f32 v73, v73
    v_smfmac_f32_32x32x32_bf16 v[24:39], v[140:143], v[96:103], v161
    v_exp_f32 v74, v74
    v_exp_f32 v75, v75
    v_exp_f32 v76, v76
    v_mfma_f32_32x32x16_bf16 v[88:103], v[132:135], v[116:119], 0
    s_add_u32 s12, s12, 2048
    s_and_b32 s12, s12, 0x7fff
    buffer_load_dwordx4 v[132:135], v157, s[48:51], s12 offen offset:0 sc1
    v_exp_f32 v77, v77
    v_exp_f32 v78, v78
    v_exp_f32 v79, v79
    v_exp_f32 v80, v80
    v_exp_f32 v81, v81
    v_exp_f32 v82, v82
    v_smfmac_f32_32x32x32_bf16 v[40:55], v[136:139], v[72:79], v161
    s_cmp_lg_u32 s15, 0
    v_exp_f32 v83, v83
    v_exp_f32 v84, v84
    v_exp_f32 v85, v85
    v_exp_f32 v86, v86
    v_exp_f32 v87, v87
    v_exp_f32 v88, v88
    v_exp_f32 v89, v89
    v_smfmac_f32_32x32x32_bf16 v[40:55], v[140:143], v[80:87], v161
    s_waitcnt vmcnt(3)
    v_exp_f32 v90, v90
    v_exp_f32 v91, v91
    v_exp_f32 v92, v92
    v_mfma_f32_32x32x16_bf16 v[72:87], v[120:123], v[104:107], 0
    v_exp_f32 v93, v93
    v_exp_f32 v94, v94
    v_exp_f32 v95, v95
    v_exp_f32 v96, v96
    v_exp_f32 v97, v97
    v_exp_f32 v98, v98
    v_smfmac_f32_32x32x32_bf16 v[56:71], v[136:139], v[88:95], v161
    s_mov_b64 exec, s[72:73]
    buffer_load_dwordx4 v[136:139], v163, s[48:51], s12 offen offset:1024 sc1
    s_mov_b64 exec, -1
    v_exp_f32 v99, v99
    v_exp_f32 v100, v100
    v_exp_f32 v101, v101
    v_exp_f32 v102, v102
    v_exp_f32 v103, v103
    s_cbranch_scc1 L_attn_30
    v_exp_f32 v72, v72
    v_exp_f32 v73, v73
    v_smfmac_f32_32x32x32_bf16 v[56:71], v[140:143], v[96:103], v161
    s_mov_b64 exec, s[72:73]
    buffer_load_dwordx4 v[140:143], v163, s[48:51], s12 offen offset:1536 sc1
    s_mov_b64 exec, -1
    v_exp_f32 v74, v74
    v_exp_f32 v75, v75
    v_exp_f32 v76, v76
    v_mfma_f32_32x32x16_bf16 v[88:103], v[120:123], v[108:111], 0
    s_waitcnt vmcnt(4)
    v_exp_f32 v77, v77
    v_exp_f32 v78, v78
    v_exp_f32 v79, v79
    v_exp_f32 v80, v80
    v_exp_f32 v81, v81
    v_exp_f32 v82, v82
    v_smfmac_f32_32x32x32_bf16 v[8:23], v[124:127], v[72:79], v161
    s_waitcnt vmcnt(3)
    v_exp_f32 v83, v83
    v_exp_f32 v84, v84
    v_exp_f32 v85, v85
    v_exp_f32 v86, v86
    v_exp_f32 v87, v87
    v_exp_f32 v88, v88
    v_exp_f32 v89, v89
    v_smfmac_f32_32x32x32_bf16 v[8:23], v[128:131], v[80:87], v161
    v_exp_f32 v90, v90
    v_exp_f32 v91, v91
    v_exp_f32 v92, v92
    v_mfma_f32_32x32x16_bf16 v[72:87], v[120:123], v[112:115], 0
    v_exp_f32 v93, v93
    v_exp_f32 v94, v94
    v_exp_f32 v95, v95
    v_exp_f32 v96, v96
    v_exp_f32 v97, v97
    v_exp_f32 v98, v98
    v_smfmac_f32_32x32x32_bf16 v[24:39], v[124:127], v[88:95], v161
    v_exp_f32 v99, v99
    v_exp_f32 v100, v100
    v_exp_f32 v101, v101
    v_exp_f32 v102, v102
    v_exp_f32 v103, v103
    v_exp_f32 v72, v72
    v_exp_f32 v73, v73
    v_smfmac_f32_32x32x32_bf16 v[24:39], v[128:131], v[96:103], v161
    v_exp_f32 v74, v74
    v_exp_f32 v75, v75
    v_exp_f32 v76, v76
    v_mfma_f32_32x32x16_bf16 v[88:103], v[120:123], v[116:119], 0
    v_exp_f32 v77, v77
    v_exp_f32 v78, v78
    v_exp_f32 v79, v79
    v_exp_f32 v80, v80
    v_exp_f32 v81, v81
    v_exp_f32 v82, v82
    v_smfmac_f32_32x32x32_bf16 v[40:55], v[124:127], v[72:79], v161
    v_exp_f32 v83, v83
    v_exp_f32 v84, v84
    v_exp_f32 v85, v85
    v_exp_f32 v86, v86
    v_exp_f32 v87, v87
    v_exp_f32 v88, v88
    v_exp_f32 v89, v89
    v_smfmac_f32_32x32x32_bf16 v[40:55], v[128:131], v[80:87], v161
    s_waitcnt vmcnt(2)
    v_exp_f32 v90, v90
    v_exp_f32 v91, v91
    v_exp_f32 v92, v92
    v_mfma_f32_32x32x16_bf16 v[72:87], v[132:135], v[104:107], 0
    v_exp_f32 v93, v93
    v_exp_f32 v94, v94
    v_exp_f32 v95, v95
    v_exp_f32 v96, v96
    v_exp_f32 v97, v97
    v_exp_f32 v98, v98
    v_smfmac_f32_32x32x32_bf16 v[56:71], v[124:127], v[88:95], v161
    v_exp_f32 v99, v99
    v_exp_f32 v100, v100
    v_exp_f32 v101, v101
    v_exp_f32 v102, v102
    v_exp_f32 v103, v103
    v_exp_f32 v72, v72
    v_exp_f32 v73, v73
    v_smfmac_f32_32x32x32_bf16 v[56:71], v[128:131], v[96:103], v161
    v_exp_f32 v74, v74
    v_exp_f32 v75, v75
    v_exp_f32 v76, v76
    v_mfma_f32_32x32x16_bf16 v[88:103], v[132:135], v[108:111], 0
    s_waitcnt vmcnt(1)
L_spin_32:
    ds_read_b32 v5, v166 offset:24
    s_waitcnt lgkmcnt(0)
    v_readfirstlane_b32 s6, v5
    s_nop 0
    s_bfe_u32 s7, s6, 0x80018
    s_cmp_ge_u32 s7, 4
    s_cbranch_scc1 L_spun_33
    s_sub_u32 s86, s86, 1
    s_cbranch_scc0 L_spin_32
    s_mov_b32 s86, 0
L_spun_33:
    ds_read_b32 v5, v166 offset:68
    s_waitcnt lgkmcnt(0)
    v_readfirstlane_b32 s70, v5
    v_lshlrev_b32 v160, 2, v0
    v_add_u32 v1, s92, v162
    v_add_u32 v2, s92, v160
    v_add_u32 v3, s93, v162
    v_add_u32 v4, s93, v160
    v_add_u32 v5, s94, v162
    v_add_u32 v6, s94, v160
    v_add_u32 v7, s95, v162
    v_add_u32 v160, s95, v160
    v_exp_f32 v77, v77
    v_exp_f32 v78, v78
    v_exp_f32 v79, v79
    v_exp_f32 v80, v80
    v_exp_f32 v81, v81
    v_exp_f32 v82, v82
    v_smfmac_f32_32x32x32_bf16 v[8:23], v[136:139], v[72:79], v161
    s_waitcnt vmcnt(0)
    v_exp_f32 v83, v83
    v_exp_f32 v84, v84
    v_exp_f32 v85, v85
    v_exp_f32 v86, v86
    v_exp_f32 v87, v87
    v_exp_f32 v88, v88
    v_exp_f32 v89, v89
    v_smfmac_f32_32x32x32_bf16 v[8:23], v[140:143], v[80:87], v161
    v_exp_f32 v90, v90
    v_exp_f32 v91, v91
    v_exp_f32 v92, v92
    v_mfma_f32_32x32x16_bf16 v[72:87], v[132:135], v[112:115], 0
    v_exp_f32 v93, v93
    v_exp_f32 v94, v94
    v_exp_f32 v95, v95
    v_exp_f32 v96, v96
    v_exp_f32 v97, v97
    v_exp_f32 v98, v98
    v_smfmac_f32_32x32x32_bf16 v[24:39], v[136:139], v[88:95], v161
    s_nop 0
    ds_write_b128 v1, v[8:11] offset:0
    v_exp_f32 v99, v99
    v_exp_f32 v100, v100
    v_exp_f32 v101, v101
    v_exp_f32 v102, v102
    v_exp_f32 v103, v103
    v_exp_f32 v72, v72
    v_exp_f32 v73, v73
    v_smfmac_f32_32x32x32_bf16 v[24:39], v[140:143], v[96:103], v161
    ds_write_b128 v1, v[12:15] offset:1024
    v_exp_f32 v74, v74
    v_exp_f32 v75, v75
    v_exp_f32 v76, v76
    v_mfma_f32_32x32x16_bf16 v[88:103], v[132:135], v[116:119], 0
    ds_write_b32 v2, v16 offset:2048
    v_exp_f32 v77, v77
    v_exp_f32 v78, v78
    v_exp_f32 v79, v79
    v_exp_f32 v80, v80
    v_exp_f32 v81, v81
    v_exp_f32 v82, v82
    v_smfmac_f32_32x32x32_bf16 v[40:55], v[136:139], v[72:79], v161
    ds_write_b128 v3, v[24:27] offset:2304
    v_exp_f32 v83, v83
    v_exp_f32 v84, v84
    v_exp_f32 v85, v85
    v_exp_f32 v86, v86
    v_exp_f32 v87, v87
    v_exp_f32 v88, v88
    v_exp_f32 v89, v89
    v_smfmac_f32_32x32x32_bf16 v[40:55], v[140:143], v[80:87], v161
    ds_write_b128 v3, v[28:31] offset:3328
    v_exp_f32 v90, v90
    v_exp_f32 v91, v91
    v_exp_f32 v92, v92
    ds_write_b32 v4, v32 offset:4352
    v_exp_f32 v93, v93
    v_exp_f32 v94, v94
    v_exp_f32 v95, v95
    v_exp_f32 v96, v96
    v_exp_f32 v97, v97
    v_exp_f32 v98, v98
    v_smfmac_f32_32x32x32_bf16 v[56:71], v[136:139], v[88:95], v161
    ds_write_b128 v5, v[40:43] offset:4608
    v_exp_f32 v99, v99
    v_exp_f32 v100, v100
    v_exp_f32 v101, v101
    v_exp_f32 v102, v102
    v_exp_f32 v103, v103
    ds_write_b128 v5, v[44:47] offset:5632
    ds_write_b32 v6, v48 offset:6656
    v_smfmac_f32_32x32x32_bf16 v[56:71], v[140:143], v[96:103], v161
    s_setprio 3
L_red_34:
    v_max3_f32 v72, v16, v32, v48
    v_min3_f32 v73, v16, v32, v48
    s_mov_b32 s6, 0x21800000
    s_nop 8
    v_max_f32 v72, v72, v64
    v_min_f32 v73, v73, v64
    v_cmp_le_f32 vcc, 0x5d800000, v72
    v_cmp_ge_f32 s[8:9], s6, v73
    s_nop 0
    s_or_b64 vcc, vcc, s[8:9]
    s_cselect_b32 s6, 0x101, s76
    v_mov_b32 v72, s6
    s_waitcnt lgkmcnt(0)
    s_mov_b64 exec, 1
    ds_add_u32 v164, v72 offset:0
    s_mov_b64 exec, -1
L_rspin_35:
    ds_read_b32 v73, v164
    ds_read_b128 v[8:11], v7 offset:0
    ds_read_b128 v[12:15], v7 offset:1024
    ds_read_b32 v16, v160 offset:2048
    ds_read_b128 v[20:23], v7 offset:2304
    ds_read_b128 v[24:27], v7 offset:3328
    ds_read_b32 v28, v160 offset:4352
    ds_read_b128 v[32:35], v7 offset:4608
    ds_read_b128 v[36:39], v7 offset:5632
    ds_read_b32 v40, v160 offset:6656
    s_waitcnt lgkmcnt(9)
    v_readfirstlane_b32 s6, v73
    s_nop 0
    s_and_b32 s7, s6, 0xff
    s_cmp_ge_u32 s7, 4
    s_cbranch_scc1 L_rspun_36
    s_waitcnt lgkmcnt(0)
    s_sub_u32 s86, s86, 1
    s_cbranch_scc0 L_rspin_35
    s_mov_b32 s86, 0
L_rspun_36:
    s_lshr_b32 s6, s6, 8
    s_cmp_gt_u32 s6, s77
    s_cbranch_scc1 L_fallback
    s_lshl_b32 s6, s11, 3
    s_lshl_b32 s6, 1, s6
    v_mov_b32 v72, s6
    s_waitcnt lgkmcnt(6)
    v_add_f32 v64, v64, v16
    v_pk_add_f32 v[56:57], v[56:57], v[8:9]
    v_pk_add_f32 v[58:59], v[58:59], v[10:11]
    v_pk_add_f32 v[60:61], v[60:61], v[12:13]
    v_pk_add_f32 v[62:63], v[62:63], v[14:15]
    s_waitcnt lgkmcnt(3)
    v_add_f32 v64, v64, v28
    v_pk_add_f32 v[56:57], v[56:57], v[20:21]
    v_pk_add_f32 v[58:59], v[58:59], v[22:23]
    v_pk_add_f32 v[60:61], v[60:61], v[24:25]
    v_pk_add_f32 v[62:63], v[62:63], v[26:27]
    s_waitcnt lgkmcnt(0)
    v_add_f32 v64, v64, v40
    v_rcp_f32 v64, v64
    v_pk_add_f32 v[56:57], v[56:57], v[32:33]
    v_pk_add_f32 v[58:59], v[58:59], v[34:35]
    v_pk_add_f32 v[60:61], v[60:61], v[36:37]
    v_pk_add_f32 v[62:63], v[62:63], v[38:39]
    v_pk_mul_f32 v[56:57], v[56:57], v[64:65] op_sel_hi:[1,0]
    v_pk_mul_f32 v[58:59], v[58:59], v[64:65] op_sel_hi:[1,0]
    v_pk_mul_f32 v[60:61], v[60:61], v[64:65] op_sel_hi:[1,0]
    v_pk_mul_f32 v[62:63], v[62:63], v[64:65] op_sel_hi:[1,0]
    v_cvt_pk_bf16_f32 v144, v56, v57
    v_cvt_pk_bf16_f32 v145, v58, v59
    v_cvt_pk_bf16_f32 v146, v60, v61
    v_cvt_pk_bf16_f32 v147, v62, v63
    v_min_u32 v144, -2, v144
    v_min_u32 v145, -2, v145
    v_min_u32 v146, -2, v146
    v_min_u32 v147, -2, v147
    s_cmp_lg_u32 s70, 0
    s_cbranch_scc0 L_thr_37
    buffer_store_dwordx4 v[144:147], v162, s[48:51], s79 offen
    s_branch L_std_38
L_thr_37:
    buffer_store_dwordx4 v[144:147], v162, s[48:51], s79 offen sc1
L_std_38:
    s_mov_b64 exec, 1
    ds_add_u32 v166, v72 offset:28
    s_mov_b64 exec, -1
L_skip:
    s_setprio 0
    s_mov_b32 s56, s36
    s_mov_b32 s57, s37
    s_mov_b32 s58, 0x200000
    s_mov_b32 s59, 0x20000
    v_lshrrev_b32 v1, 3, v0
    v_and_b32 v2, 7, v0
    v_lshlrev_b32 v3, 4, v2
    v_lshl_add_u32 v4, v1, 10, v3
    s_lshl_b32 s7, s4, 7
    s_add_u32 s81, s81, s7
    s_mul_i32 s6, s87, 2176
    s_add_u32 s6, s6, 67584
    v_mul_u32_u24 v5, 272, v1
    v_lshl_add_u32 v5, v2, 5, v5
    v_add_u32 v5, s6, v5
    v_lshl_add_u32 v104, s87, 3, v1
    v_lshlrev_b32 v105, 1, v2
    v_xor_b32 v105, v105, v104
    v_and_b32 v105, 15, v105
    v_lshlrev_b32 v105, 4, v105
    v_lshl_add_u32 v104, v104, 8, v105
    v_xor_b32 v105, 16, v104
    v_lshlrev_b32 v80, 16, v152
    v_and_b32 v81, 0xffff0000, v152
    v_lshlrev_b32 v88, 16, v148
    v_and_b32 v89, 0xffff0000, v148
    v_lshlrev_b32 v82, 16, v153
    v_and_b32 v83, 0xffff0000, v153
    v_lshlrev_b32 v90, 16, v149
    v_and_b32 v91, 0xffff0000, v149
    v_lshlrev_b32 v84, 16, v154
    v_and_b32 v85, 0xffff0000, v154
    v_lshlrev_b32 v92, 16, v150
    v_and_b32 v93, 0xffff0000, v150
    v_lshlrev_b32 v86, 16, v155
    v_and_b32 v87, 0xffff0000, v155
    v_lshlrev_b32 v94, 16, v151
    v_and_b32 v95, 0xffff0000, v151
    v_pk_add_f32 v[80:81], v[80:81], v[88:89]
    v_pk_add_f32 v[82:83], v[82:83], v[90:91]
    v_pk_add_f32 v[84:85], v[84:85], v[92:93]
    v_pk_add_f32 v[86:87], v[86:87], v[94:95]
L_b3:
    s_barrier
    ds_read_b128 v[8:11], v5 offset:0
    ds_read_b128 v[12:15], v5 offset:16
    ds_read_b128 v[16:19], v5 offset:20480
    ds_read_b128 v[20:23], v5 offset:20496
    ds_read_b128 v[24:27], v5 offset:40960
    ds_read_b128 v[28:31], v5 offset:40976
    ds_read_b128 v[32:35], v5 offset:61440
    ds_read_b128 v[36:39], v5 offset:61456
    s_waitcnt lgkmcnt(6)
    v_pk_add_f32 v[80:81], v[80:81], v[8:9]
    v_pk_add_f32 v[82:83], v[82:83], v[10:11]
    v_pk_add_f32 v[84:85], v[84:85], v[12:13]
    v_pk_add_f32 v[86:87], v[86:87], v[14:15]
    s_waitcnt lgkmcnt(4)
    v_pk_add_f32 v[80:81], v[80:81], v[16:17]
    v_pk_add_f32 v[82:83], v[82:83], v[18:19]
    v_pk_add_f32 v[84:85], v[84:85], v[20:21]
    v_pk_add_f32 v[86:87], v[86:87], v[22:23]
    s_waitcnt lgkmcnt(2)
    v_pk_add_f32 v[80:81], v[80:81], v[24:25]
    v_pk_add_f32 v[82:83], v[82:83], v[26:27]
    v_pk_add_f32 v[84:85], v[84:85], v[28:29]
    v_pk_add_f32 v[86:87], v[86:87], v[30:31]
    s_waitcnt lgkmcnt(0)
    v_pk_add_f32 v[80:81], v[80:81], v[32:33]
    v_pk_add_f32 v[82:83], v[82:83], v[34:35]
    v_pk_add_f32 v[84:85], v[84:85], v[36:37]
    v_pk_add_f32 v[86:87], v[86:87], v[38:39]
    v_cvt_pk_bf16_f32 v8, v80, v81
    v_cvt_pk_bf16_f32 v9, v82, v83
    v_cvt_pk_bf16_f32 v10, v84, v85
    v_cvt_pk_bf16_f32 v11, v86, v87
    buffer_store_dwordx4 v[8:11], v4, s[56:59], s81 offen nt
    s_or_b32 s6, s2, s3
    s_cmp_lg_u32 s6, 0
    s_cbranch_scc1 L_fin
    v_mov_b32 v1, s43
    s_mov_b32 s6, 13762560
    s_mov_b64 exec, 1
    buffer_store_dword v1, off, s[48:51], s6 sc1
L_fin:
    s_endpgm
L_fallback:
    s_waitcnt vmcnt(0) lgkmcnt(0)
    s_mov_b32 s12, 0
    s_mov_b32 s15, 16
    v_mov_b32 v165, 1
    v_mov_b32 v88, 0xff800000
    v_mov_b32 v89, 0xff800000
    v_mov_b32 v90, 0xff800000
    v_mov_b32 v91, 0xff800000
L_fbmax_39:
    buffer_load_dwordx4 v[120:123], v157, s[48:51], s12 offen offset:0 sc1
    s_waitcnt vmcnt(0)
    v_mfma_f32_32x32x16_bf16 v[72:87], v[120:123], v[104:107], 0
    s_nop 15
    v_max3_f32 v88, v88, v72, v73
    v_max3_f32 v88, v88, v74, v75
    v_max3_f32 v88, v88, v76, v77
    v_max3_f32 v88, v88, v78, v79
    v_max3_f32 v88, v88, v80, v81
    v_max3_f32 v88, v88, v82, v83
    v_max3_f32 v88, v88, v84, v85
    v_max3_f32 v88, v88, v86, v87
    s_nop 1
    v_mfma_f32_32x32x16_bf16 v[72:87], v[120:123], v[108:111], 0
    s_nop 15
    v_max3_f32 v89, v89, v72, v73
    v_max3_f32 v89, v89, v74, v75
    v_max3_f32 v89, v89, v76, v77
    v_max3_f32 v89, v89, v78, v79
    v_max3_f32 v89, v89, v80, v81
    v_max3_f32 v89, v89, v82, v83
    v_max3_f32 v89, v89, v84, v85
    v_max3_f32 v89, v89, v86, v87
    s_nop 1
    v_mfma_f32_32x32x16_bf16 v[72:87], v[120:123], v[112:115], 0
    s_nop 15
    v_max3_f32 v90, v90, v72, v73
    v_max3_f32 v90, v90, v74, v75
    v_max3_f32 v90, v90, v76, v77
    v_max3_f32 v90, v90, v78, v79
    v_max3_f32 v90, v90, v80, v81
    v_max3_f32 v90, v90, v82, v83
    v_max3_f32 v90, v90, v84, v85
    v_max3_f32 v90, v90, v86, v87
    s_nop 1
    v_mfma_f32_32x32x16_bf16 v[72:87], v[120:123], v[116:119], 0
    s_nop 15
    v_max3_f32 v91, v91, v72, v73
    v_max3_f32 v91, v91, v74, v75
    v_max3_f32 v91, v91, v76, v77
    v_max3_f32 v91, v91, v78, v79
    v_max3_f32 v91, v91, v80, v81
    v_max3_f32 v91, v91, v82, v83
    v_max3_f32 v91, v91, v84, v85
    v_max3_f32 v91, v91, v86, v87
    s_nop 1
    s_add_u32 s12, s12, 2048
    s_sub_u32 s15, s15, 1
    s_cmp_lg_u32 s15, 0
    s_cbranch_scc1 L_fbmax_39
    v_mov_b32 v96, v88
    s_nop 1
    v_permlane32_swap_b32 v88, v96
    s_nop 1
    v_max_f32 v88, v88, v96
    v_mov_b32 v96, v89
    s_nop 1
    v_permlane32_swap_b32 v89, v96
    s_nop 1
    v_max_f32 v89, v89, v96
    v_mov_b32 v96, v90
    s_nop 1
    v_permlane32_swap_b32 v90, v96
    s_nop 1
    v_max_f32 v90, v90, v96
    v_mov_b32 v96, v91
    s_nop 1
    v_permlane32_swap_b32 v91, v96
    s_nop 1
    v_max_f32 v91, v91, v96
    v_lshlrev_b32 v96, 2, v0
    s_lshl_b32 s6, s10, 8
    v_add_u32 v92, s88, v96
    v_add_u32 v97, s6, v92
    ds_write_b32 v97, v88
    v_add_u32 v93, s89, v96
    v_add_u32 v97, s6, v93
    ds_write_b32 v97, v89
    v_add_u32 v94, s90, v96
    v_add_u32 v97, s6, v94
    ds_write_b32 v97, v90
    v_add_u32 v95, s91, v96
    v_add_u32 v97, s6, v95
    ds_write_b32 v97, v91
    s_waitcnt lgkmcnt(0)
    s_mov_b64 exec, 1
    ds_add_u32 v164, v165 offset:16
    s_mov_b64 exec, -1
L_spin_40:
    ds_read_b32 v96, v164 offset:16
    s_waitcnt lgkmcnt(0)
    v_readfirstlane_b32 s6, v96
    s_nop 0
    s_bfe_u32 s7, s6, 0x80000
    s_cmp_ge_u32 s7, 4
    s_cbranch_scc1 L_spun_41
    s_sub_u32 s86, s86, 1
    s_cbranch_scc0 L_spin_40
    s_mov_b32 s86, 0
L_spun_41:
    ds_read_b32 v72, v92 offset:0
    ds_read_b32 v73, v92 offset:256
    ds_read_b32 v74, v92 offset:512
    ds_read_b32 v75, v92 offset:768
    s_waitcnt lgkmcnt(0)
    v_max3_f32 v88, v72, v73, v74
    v_max_f32 v88, v88, v75
    ds_read_b32 v72, v93 offset:0
    ds_read_b32 v73, v93 offset:256
    ds_read_b32 v74, v93 offset:512
    ds_read_b32 v75, v93 offset:768
    s_waitcnt lgkmcnt(0)
    v_max3_f32 v89, v72, v73, v74
    v_max_f32 v89, v89, v75
    ds_read_b32 v72, v94 offset:0
    ds_read_b32 v73, v94 offset:256
    ds_read_b32 v74, v94 offset:512
    ds_read_b32 v75, v94 offset:768
    s_waitcnt lgkmcnt(0)
    v_max3_f32 v90, v72, v73, v74
    v_max_f32 v90, v90, v75
    ds_read_b32 v72, v95 offset:0
    ds_read_b32 v73, v95 offset:256
    ds_read_b32 v74, v95 offset:512
    ds_read_b32 v75, v95 offset:768
    s_waitcnt lgkmcnt(0)
    v_max3_f32 v91, v72, v73, v74
    v_max_f32 v91, v91, v75
    v_mov_b32 v8, 0
    v_mov_b32 v9, 0
    v_mov_b32 v10, 0
    v_mov_b32 v11, 0
    v_mov_b32 v12, 0
    v_mov_b32 v13, 0
    v_mov_b32 v14, 0
    v_mov_b32 v15, 0
    v_mov_b32 v16, 0
    v_mov_b32 v17, 0
    v_mov_b32 v18, 0
    v_mov_b32 v19, 0
    v_mov_b32 v20, 0
    v_mov_b32 v21, 0
    v_mov_b32 v22, 0
    v_mov_b32 v23, 0
    v_mov_b32 v24, 0
    v_mov_b32 v25, 0
    v_mov_b32 v26, 0
    v_mov_b32 v27, 0
    v_mov_b32 v28, 0
    v_mov_b32 v29, 0
    v_mov_b32 v30, 0
    v_mov_b32 v31, 0
    v_mov_b32 v32, 0
    v_mov_b32 v33, 0
    v_mov_b32 v34, 0
    v_mov_b32 v35, 0
    v_mov_b32 v36, 0
    v_mov_b32 v37, 0
    v_mov_b32 v38, 0
    v_mov_b32 v39, 0
    v_mov_b32 v40, 0
    v_mov_b32 v41, 0
    v_mov_b32 v42, 0
    v_mov_b32 v43, 0
    v_mov_b32 v44, 0
    v_mov_b32 v45, 0
    v_mov_b32 v46, 0
    v_mov_b32 v47, 0
    v_mov_b32 v48, 0
    v_mov_b32 v49, 0
    v_mov_b32 v50, 0
    v_mov_b32 v51, 0
    v_mov_b32 v52, 0
    v_mov_b32 v53, 0
    v_mov_b32 v54, 0
    v_mov_b32 v55, 0
    v_mov_b32 v56, 0
    v_mov_b32 v57, 0
    v_mov_b32 v58, 0
    v_mov_b32 v59, 0
    v_mov_b32 v60, 0
    v_mov_b32 v61, 0
    v_mov_b32 v62, 0
    v_mov_b32 v63, 0
    v_mov_b32 v64, 0
    v_mov_b32 v65, 0
    v_mov_b32 v66, 0
    v_mov_b32 v67, 0
    v_mov_b32 v68, 0
    v_mov_b32 v69, 0
    v_mov_b32 v70, 0
    v_mov_b32 v71, 0
    s_mov_b32 s12, 0
    s_mov_b32 s15, 16
L_fbpv_42:
    buffer_load_dwordx4 v[120:123], v157, s[48:51], s12 offen offset:0 sc1
    s_mov_b64 exec, s[72:73]
    buffer_load_dwordx4 v[124:127], v163, s[48:51], s12 offen offset:1024 sc1
    s_mov_b64 exec, -1
    s_mov_b64 exec, s[72:73]
    buffer_load_dwordx4 v[128:131], v163, s[48:51], s12 offen offset:1536 sc1
    s_mov_b64 exec, -1
    s_waitcnt vmcnt(0)
    v_mfma_f32_32x32x16_bf16 v[72:87], v[120:123], v[104:107], 0
    s_nop 15
    v_sub_f32 v72, v72, v88
    v_sub_f32 v73, v73, v88
    v_sub_f32 v74, v74, v88
    v_sub_f32 v75, v75, v88
    v_sub_f32 v76, v76, v88
    v_sub_f32 v77, v77, v88
    v_sub_f32 v78, v78, v88
    v_sub_f32 v79, v79, v88
    v_sub_f32 v80, v80, v88
    v_sub_f32 v81, v81, v88
    v_sub_f32 v82, v82, v88
    v_sub_f32 v83, v83, v88
    v_sub_f32 v84, v84, v88
    v_sub_f32 v85, v85, v88
    v_sub_f32 v86, v86, v88
    v_sub_f32 v87, v87, v88
    v_exp_f32 v72, v72
    v_exp_f32 v73, v73
    v_exp_f32 v74, v74
    v_exp_f32 v75, v75
    v_exp_f32 v76, v76
    v_exp_f32 v77, v77
    v_exp_f32 v78, v78
    v_exp_f32 v79, v79
    v_exp_f32 v80, v80
    v_exp_f32 v81, v81
    v_exp_f32 v82, v82
    v_exp_f32 v83, v83
    v_exp_f32 v84, v84
    v_exp_f32 v85, v85
    v_exp_f32 v86, v86
    v_exp_f32 v87, v87
    s_nop 1
    v_smfmac_f32_32x32x32_bf16 v[8:23], v[124:127], v[72:79], v161
    v_smfmac_f32_32x32x32_bf16 v[8:23], v[128:131], v[80:87], v161
    v_mfma_f32_32x32x16_bf16 v[72:87], v[120:123], v[108:111], 0
    s_nop 15
    v_sub_f32 v72, v72, v89
    v_sub_f32 v73, v73, v89
    v_sub_f32 v74, v74, v89
    v_sub_f32 v75, v75, v89
    v_sub_f32 v76, v76, v89
    v_sub_f32 v77, v77, v89
    v_sub_f32 v78, v78, v89
    v_sub_f32 v79, v79, v89
    v_sub_f32 v80, v80, v89
    v_sub_f32 v81, v81, v89
    v_sub_f32 v82, v82, v89
    v_sub_f32 v83, v83, v89
    v_sub_f32 v84, v84, v89
    v_sub_f32 v85, v85, v89
    v_sub_f32 v86, v86, v89
    v_sub_f32 v87, v87, v89
    v_exp_f32 v72, v72
    v_exp_f32 v73, v73
    v_exp_f32 v74, v74
    v_exp_f32 v75, v75
    v_exp_f32 v76, v76
    v_exp_f32 v77, v77
    v_exp_f32 v78, v78
    v_exp_f32 v79, v79
    v_exp_f32 v80, v80
    v_exp_f32 v81, v81
    v_exp_f32 v82, v82
    v_exp_f32 v83, v83
    v_exp_f32 v84, v84
    v_exp_f32 v85, v85
    v_exp_f32 v86, v86
    v_exp_f32 v87, v87
    s_nop 1
    v_smfmac_f32_32x32x32_bf16 v[24:39], v[124:127], v[72:79], v161
    v_smfmac_f32_32x32x32_bf16 v[24:39], v[128:131], v[80:87], v161
    v_mfma_f32_32x32x16_bf16 v[72:87], v[120:123], v[112:115], 0
    s_nop 15
    v_sub_f32 v72, v72, v90
    v_sub_f32 v73, v73, v90
    v_sub_f32 v74, v74, v90
    v_sub_f32 v75, v75, v90
    v_sub_f32 v76, v76, v90
    v_sub_f32 v77, v77, v90
    v_sub_f32 v78, v78, v90
    v_sub_f32 v79, v79, v90
    v_sub_f32 v80, v80, v90
    v_sub_f32 v81, v81, v90
    v_sub_f32 v82, v82, v90
    v_sub_f32 v83, v83, v90
    v_sub_f32 v84, v84, v90
    v_sub_f32 v85, v85, v90
    v_sub_f32 v86, v86, v90
    v_sub_f32 v87, v87, v90
    v_exp_f32 v72, v72
    v_exp_f32 v73, v73
    v_exp_f32 v74, v74
    v_exp_f32 v75, v75
    v_exp_f32 v76, v76
    v_exp_f32 v77, v77
    v_exp_f32 v78, v78
    v_exp_f32 v79, v79
    v_exp_f32 v80, v80
    v_exp_f32 v81, v81
    v_exp_f32 v82, v82
    v_exp_f32 v83, v83
    v_exp_f32 v84, v84
    v_exp_f32 v85, v85
    v_exp_f32 v86, v86
    v_exp_f32 v87, v87
    s_nop 1
    v_smfmac_f32_32x32x32_bf16 v[40:55], v[124:127], v[72:79], v161
    v_smfmac_f32_32x32x32_bf16 v[40:55], v[128:131], v[80:87], v161
    v_mfma_f32_32x32x16_bf16 v[72:87], v[120:123], v[116:119], 0
    s_nop 15
    v_sub_f32 v72, v72, v91
    v_sub_f32 v73, v73, v91
    v_sub_f32 v74, v74, v91
    v_sub_f32 v75, v75, v91
    v_sub_f32 v76, v76, v91
    v_sub_f32 v77, v77, v91
    v_sub_f32 v78, v78, v91
    v_sub_f32 v79, v79, v91
    v_sub_f32 v80, v80, v91
    v_sub_f32 v81, v81, v91
    v_sub_f32 v82, v82, v91
    v_sub_f32 v83, v83, v91
    v_sub_f32 v84, v84, v91
    v_sub_f32 v85, v85, v91
    v_sub_f32 v86, v86, v91
    v_sub_f32 v87, v87, v91
    v_exp_f32 v72, v72
    v_exp_f32 v73, v73
    v_exp_f32 v74, v74
    v_exp_f32 v75, v75
    v_exp_f32 v76, v76
    v_exp_f32 v77, v77
    v_exp_f32 v78, v78
    v_exp_f32 v79, v79
    v_exp_f32 v80, v80
    v_exp_f32 v81, v81
    v_exp_f32 v82, v82
    v_exp_f32 v83, v83
    v_exp_f32 v84, v84
    v_exp_f32 v85, v85
    v_exp_f32 v86, v86
    v_exp_f32 v87, v87
    s_nop 1
    v_smfmac_f32_32x32x32_bf16 v[56:71], v[124:127], v[72:79], v161
    v_smfmac_f32_32x32x32_bf16 v[56:71], v[128:131], v[80:87], v161
    s_add_u32 s12, s12, 2048
    s_sub_u32 s15, s15, 1
    s_cmp_lg_u32 s15, 0
    s_cbranch_scc1 L_fbpv_42
    s_mov_b32 s77, 0xffffff
    v_add_u32 v164, 8, v164
    s_nop 15
    ds_write_b128 v1, v[8:11] offset:0
    ds_write_b128 v1, v[12:15] offset:1024
    ds_write_b32 v2, v16 offset:2048
    ds_write_b128 v3, v[24:27] offset:2304
    ds_write_b128 v3, v[28:31] offset:3328
    ds_write_b32 v4, v32 offset:4352
    ds_write_b128 v5, v[40:43] offset:4608
    ds_write_b128 v5, v[44:47] offset:5632
    ds_write_b32 v6, v48 offset:6656
    s_branch L_red_34
L_G:
    s_setprio 3
    v_mov_b32 v164, 157952
    v_mov_b32 v8, 0
    v_and_b32 v9, 15, v0
    v_lshl_add_u32 v9, v9, 2, v164
    ds_write_b32 v9, v8
    s_sub_u32 s10, s3, 8
    v_lshlrev_b32 v161, 4, v0
    s_and_b32 s11, s5, 3
    v_mov_b32 v165, 1
    v_mov_b32 v9, 0x100
    s_lshl_b32 s8, s10, 10
    s_lshl_b32 s9, s4, 7
    s_and_b32 s12, s5, 3
    s_lshl_b32 s12, s12, 14
    s_add_u32 s12, s12, s8
    v_lshrrev_b32 v160, 3, v0
    v_and_b32 v3, 2, v160
    v_lshlrev_b32 v3, 1, v3
    v_xor_b32 v3, v3, v0
    v_and_b32 v3, 7, v3
    v_mul_u32_u24 v160, 1024, v160
    v_lshl_add_u32 v160, v3, 4, v160
    s_waitcnt lgkmcnt(0)
    s_barrier
    s_mov_b32 s52, s18
    s_mov_b32 s53, s19
    s_mov_b32 s54, 0x80000
    s_mov_b32 s55, 0x20000
    s_setprio 0
    s_add_u32 m0, s12, 67584
    s_lshl3_add_u32 s7, s12, s9
    s_add_u32 s12, s12, 4096
    s_and_b32 s12, s12, 0xffff
    buffer_load_dwordx4 v160, s[52:55], s7 offen lds
    s_add_u32 m0, s12, 67584
    s_lshl3_add_u32 s7, s12, s9
    s_add_u32 s12, s12, 4096
    s_and_b32 s12, s12, 0xffff
    buffer_load_dwordx4 v160, s[52:55], s7 offen lds
    s_add_u32 m0, s12, 67584
    s_lshl3_add_u32 s7, s12, s9
    s_add_u32 s12, s12, 4096
    s_and_b32 s12, s12, 0xffff
    buffer_load_dwordx4 v160, s[52:55], s7 offen lds
    s_add_u32 m0, s12, 67584
    s_lshl3_add_u32 s7, s12, s9
    s_add_u32 s12, s12, 4096
    s_and_b32 s12, s12, 0xffff
    buffer_load_dwordx4 v160, s[52:55], s7 offen lds
    s_add_u32 m0, s12, 67584
    s_lshl3_add_u32 s7, s12, s9
    s_add_u32 s12, s12, 4096
    s_and_b32 s12, s12, 0xffff
    buffer_load_dwordx4 v160, s[52:55], s7 offen lds
    s_add_u32 m0, s12, 67584
    s_lshl3_add_u32 s7, s12, s9
    s_add_u32 s12, s12, 4096
    s_and_b32 s12, s12, 0xffff
    buffer_load_dwordx4 v160, s[52:55], s7 offen lds
    s_add_u32 m0, s12, 67584
    s_lshl3_add_u32 s7, s12, s9
    s_add_u32 s12, s12, 4096
    s_and_b32 s12, s12, 0xffff
    buffer_load_dwordx4 v160, s[52:55], s7 offen lds
    s_add_u32 m0, s12, 67584
    s_lshl3_add_u32 s7, s12, s9
    s_add_u32 s12, s12, 4096
    s_and_b32 s12, s12, 0xffff
    buffer_load_dwordx4 v160, s[52:55], s7 offen lds
    s_add_u32 m0, s12, 67584
    s_lshl3_add_u32 s7, s12, s9
    s_add_u32 s12, s12, 4096
    s_and_b32 s12, s12, 0xffff
    buffer_load_dwordx4 v160, s[52:55], s7 offen lds
    s_add_u32 m0, s12, 67584
    s_lshl3_add_u32 s7, s12, s9
    s_add_u32 s12, s12, 4096
    s_and_b32 s12, s12, 0xffff
    buffer_load_dwordx4 v160, s[52:55], s7 offen lds
    s_add_u32 m0, s12, 67584
    s_lshl3_add_u32 s7, s12, s9
    s_add_u32 s12, s12, 4096
    s_and_b32 s12, s12, 0xffff
    buffer_load_dwordx4 v160, s[52:55], s7 offen lds
    s_add_u32 m0, s12, 67584
    s_lshl3_add_u32 s7, s12, s9
    s_add_u32 s12, s12, 4096
    s_and_b32 s12, s12, 0xffff
    buffer_load_dwordx4 v160, s[52:55], s7 offen lds
    s_add_u32 m0, s12, 67584
    s_lshl3_add_u32 s7, s12, s9
    s_add_u32 s12, s12, 4096
    s_and_b32 s12, s12, 0xffff
    buffer_load_dwordx4 v160, s[52:55], s7 offen lds
    s_add_u32 m0, s12, 67584
    s_lshl3_add_u32 s7, s12, s9
    s_add_u32 s12, s12, 4096
    s_and_b32 s12, s12, 0xffff
    buffer_load_dwordx4 v160, s[52:55], s7 offen lds
    s_add_u32 m0, s12, 67584
    s_lshl3_add_u32 s7, s12, s9
    s_add_u32 s12, s12, 4096
    s_and_b32 s12, s12, 0xffff
    buffer_load_dwordx4 v160, s[52:55], s7 offen lds
    s_add_u32 m0, s12, 67584
    s_lshl3_add_u32 s7, s12, s9
    s_add_u32 s12, s12, 4096
    s_and_b32 s12, s12, 0xffff
    buffer_load_dwordx4 v160, s[52:55], s7 offen lds
    s_mov_b32 s48, s40
    s_mov_b32 s49, s41
    s_mov_b32 s50, 0x1000000
    s_mov_b32 s51, 0x20000
    s_waitcnt vmcnt(0) lgkmcnt(0)
    s_setprio 3
    s_mov_b64 exec, 1
    ds_add_u32 v164, v9 offset:32
    s_mov_b64 exec, -1
    s_setprio 0
    s_mov_b32 s60, s28
    s_mov_b32 s61, s29
    s_mov_b32 s62, 0x1c0000
    s_mov_b32 s63, 0x20000
    s_mov_b32 s44, s30
    s_mov_b32 s45, s31
    s_mov_b32 s46, 0xe00
    s_mov_b32 s47, 0x20000
    s_mov_b32 s52, s32
    s_mov_b32 s53, s33
    s_mov_b32 s54, 0x1c0000
    s_mov_b32 s55, 0x20000
    s_mov_b32 s56, s24
    s_mov_b32 s57, s25
    s_mov_b32 s58, 0x80000
    s_mov_b32 s59, 0x20000
    s_and_b32 s6, s4, 1
    s_add_u32 s7, s10, s6
    s_and_b32 s7, s7, 3
    s_lshl_b32 s7, s7, 7
    s_mul_i32 s12, s4, 448
    s_add_u32 s12, s12, s7
    s_lshl_b32 s7, s6, 6
    s_sub_u32 s12, s12, s7
    s_mul_i32 s14, s10, 20480
    s_add_u32 s14, s14, 67584
    s_cmp_eq_u32 s10, 3
    s_cselect_b32 s7, s7, 0
    s_add_u32 s13, s12, s7
    s_mul_i32 s8, s11, 458752
    s_add_u32 s12, s12, s8
    v_lshrrev_b32 v1, 3, v0
    v_and_b32 v2, 2, v1
    v_lshlrev_b32 v2, 1, v2
    v_xor_b32 v2, v2, v0
    v_and_b32 v2, 7, v2
    v_mul_u32_u24 v1, 3584, v1
    v_lshl_add_u32 v1, v2, 4, v1
    v_lshrrev_b32 v2, 5, v0
    v_lshlrev_b32 v2, 10, v2
    v_bfe_u32 v3, v0, 2, 2
    v_lshl_add_u32 v2, v3, 7, v2
    v_lshrrev_b32 v3, 1, v3
    v_lshl_add_u32 v2, v3, 6, v2
    v_bfe_u32 v3, v0, 4, 1
    v_lshl_add_u32 v2, v3, 5, v2
    v_and_b32 v3, 3, v0
    v_lshl_add_u32 v2, v3, 3, v2
    v_xor_b32 v2, s7, v2
    v_add_u32 v2, s14, v2
    v_xor_b32 v3, 64, v2
    v_lshrrev_b32 v5, 5, v0
    v_mul_u32_u24 v5, 528, v5
    v_and_b32 v158, 31, v0
    v_lshl_add_u32 v158, v158, 4, v5
    v_and_b32 v5, 31, v0
    v_lshlrev_b32 v5, 2, v5
    v_add_u32 v5, 149504, v5
    v_lshrrev_b32 v6, 5, v0
    v_lshlrev_b32 v6, 3, v6
    buffer_load_dwordx2 v[120:121], v6, s[44:47], s13 offen offset:0
    buffer_load_dwordx2 v[122:123], v6, s[44:47], s13 offen offset:16
    buffer_load_dwordx2 v[124:125], v6, s[44:47], s13 offen offset:32
    buffer_load_dwordx2 v[126:127], v6, s[44:47], s13 offen offset:48
    buffer_load_dwordx2 v[128:129], v6, s[44:47], s13 offen offset:64
    buffer_load_dwordx2 v[130:131], v6, s[44:47], s13 offen offset:80
    buffer_load_dwordx2 v[132:133], v6, s[44:47], s13 offen offset:96
    buffer_load_dwordx2 v[134:135], v6, s[44:47], s13 offen offset:112
    v_lshrrev_b32 v162, 5, v0
    v_lshlrev_b32 v162, 9, v162
    v_bfe_u32 v8, v0, 2, 2
    v_lshl_add_u32 v162, v8, 7, v162
    v_lshrrev_b32 v8, 1, v8
    v_lshl_add_u32 v162, v8, 6, v162
    v_bfe_u32 v8, v0, 4, 1
    v_lshl_add_u32 v162, v8, 5, v162
    v_and_b32 v8, 3, v0
    v_lshl_add_u32 v162, v8, 3, v162
    v_add_u32 v162, s14, v162
    v_xor_b32 v163, 64, v162
    s_mul_i32 s7, s5, 224
    s_mul_i32 s8, s10, 28
    s_add_u32 s7, s7, s8
    s_lshl_b32 s7, s7, 10
    s_add_u32 s82, s7, 5242880
    s_add_u32 s83, s82, 114688
    s_lshl_b32 s9, s4, 7
    s_lshl_b32 s68, s8, 14
    s_add_u32 s68, s68, s9
    s_mov_b32 s88, 0x12829020
    s_mov_b32 s89, 0x2307b9ac
    s_mov_b32 s90, 0x62ce2b4
    s_mov_b32 s91, 0x2725a8e6
    s_mov_b32 s92, 0xdeaf6
    s_add_u32 s6, s5, s4
    s_and_b32 s6, s6, 3
    s_cmp_eq_u32 s6, 1
    s_cselect_b32 s88, 0x1ee6b128, s88
    s_cselect_b32 s89, 0x338ad230, s89
    s_cselect_b32 s90, 0x14729020, s90
    s_cselect_b32 s91, 0x357b4e4b, s91
    s_cselect_b32 s92, 0x30c5b, s92
    s_cmp_eq_u32 s6, 2
    s_cselect_b32 s88, 0x2b48c1ee, s88
    s_cselect_b32 s89, 0xa408338, s89
    s_cselect_b32 s90, 0x2726b128, s90
    s_cselect_b32 s91, 0x62deaf6, s91
    s_cselect_b32 s92, 0x5a8e6, s92
    s_cmp_eq_u32 s6, 3
    s_cselect_b32 s88, 0x20ce2b4, s88
    s_cselect_b32 s89, 0x1ac4a0a4, s89
    s_cselect_b32 s90, 0x3578c1ee, s90
    s_cselect_b32 s91, 0x14730c5b, s91
    s_cselect_b32 s92, 0xb4e4b, s92
    v_and_b32 v8, 3, v0
    v_min_u32 v8, 6, v8
    v_bfe_u32 v9, v0, 3, 1
    v_lshlrev_b32 v9, 7, v9
    v_lshl_add_u32 v159, v8, 2, v9
    s_lshl_b32 s6, s5, 3
    s_lshl1_add_u32 s6, s10, s6
    s_lshl_b32 s6, s6, 7
    s_add_u32 s80, s6, 13697024
    v_and_b32 v8, 3, v0
    v_add_u32 v166, 16, v159
    v_cmp_eq_u32 vcc, 3, v8
    s_lshl_b32 s69, s10, 17
    s_lshl_b32 s9, s4, 7
    v_cndmask_b32 v166, v166, v159, vcc
    s_add_u32 s69, s69, s9
    s_lshl_b32 s6, s5, 6
    s_lshl3_add_u32 s6, s10, s6
    s_lshl_b32 s6, s6, 10
    s_add_u32 s84, s6, 3145728
    s_add_u32 s85, s84, 32768
    s_lshl_b32 s6, s42, 7
    s_lshl2_add_u32 s6, s10, s6
    s_add_u32 s79, s6, 13697024
    s_setprio 3
L_spin_43:
    ds_read_b32 v8, v164 offset:36
    s_waitcnt lgkmcnt(0)
    v_readfirstlane_b32 s6, v8
    s_nop 0
    s_bfe_u32 s7, s6, 0x80008
    s_cmp_ge_u32 s7, 5
    s_cbranch_scc1 L_spun_44
    s_sleep 2
    s_sub_u32 s86, s86, 1
    s_cbranch_scc0 L_spin_43
    s_mov_b32 s86, 0
L_spun_44:
    ds_read_b32 v8, v164 offset:64
    s_waitcnt lgkmcnt(0)
    v_readfirstlane_b32 s43, v8
L_spin_45:
    ds_read_b32 v8, v164 offset:56
    s_waitcnt lgkmcnt(0)
    v_readfirstlane_b32 s6, v8
    s_nop 0
    s_bfe_u32 s7, s6, 0x80000
    s_cmp_ge_u32 s7, 4
    s_cbranch_scc1 L_spun_46
    s_sleep 1
    s_sub_u32 s86, s86, 1
    s_cbranch_scc0 L_spin_45
    s_mov_b32 s86, 0
L_spun_46:
    ds_read_b32 v8, v164 offset:68
    s_waitcnt lgkmcnt(0)
    v_readfirstlane_b32 s70, v8
    s_setprio 3
    s_cmp_eq_u32 s10, 3
    s_cbranch_scc1 L_f1w3_47
    s_add_u32 m0, s14, 0
    s_nop 0
    s_setprio 0
    buffer_load_dwordx4 v1, s[60:63], s12 offen lds
    s_setprio 3
    s_add_u32 m0, s14, 1024
    s_add_u32 s12, s12, 28672
    s_setprio 0
    buffer_load_dwordx4 v1, s[60:63], s12 offen lds
    s_setprio 3
    s_add_u32 m0, s14, 2048
    s_add_u32 s12, s12, 28672
    s_setprio 0
    buffer_load_dwordx4 v1, s[60:63], s12 offen lds
    s_setprio 3
    s_add_u32 m0, s14, 3072
    s_add_u32 s12, s12, 28672
    s_setprio 0
    buffer_load_dwordx4 v1, s[60:63], s12 offen lds
    s_setprio 3
    s_add_u32 m0, s14, 4096
    s_add_u32 s12, s12, 28672
    s_setprio 0
    buffer_load_dwordx4 v1, s[60:63], s12 offen lds
    s_setprio 3
    s_add_u32 m0, s14, 5120
    s_add_u32 s12, s12, 28672
    s_setprio 0
    buffer_load_dwordx4 v1, s[60:63], s12 offen lds
    s_setprio 3
    ds_read_b32 v152, v5 offset:0
    ds_read_b32 v154, v5 offset:128
    s_add_u32 s6, s11, 0
    s_and_b32 s6, s6, 3
    s_mul_i32 s6, s6, 8448
    s_add_u32 s7, s6, 33792
    v_add_u32 v4, s6, v158
    v_add_u32 v7, s7, v158
    s_waitcnt vmcnt(4)
    ds_read_b64_tr_b16 v[72:73], v2 offset:0
    ds_read_b64_tr_b16 v[74:75], v2 offset:512
    ds_read_b64_tr_b16 v[76:77], v3 offset:0
    ds_read_b64_tr_b16 v[78:79], v3 offset:512
    ds_read_b128 v[80:83], v4 offset:0
    ds_read_b128 v[84:87], v7 offset:0
    s_waitcnt vmcnt(2)
    s_waitcnt lgkmcnt(0)
    v_mfma_f32_32x32x16_bf16 v[8:23], v[72:75], v[80:83], 0
    ds_read_b64_tr_b16 v[88:89], v2 offset:2048
    ds_read_b64_tr_b16 v[90:91], v2 offset:2560
    s_add_u32 m0, s14, 6144
    s_add_u32 s12, s12, 28672
    s_setprio 0
    buffer_load_dwordx4 v1, s[60:63], s12 offen lds
    s_setprio 3
    s_waitcnt lgkmcnt(1)
    v_mfma_f32_32x32x16_bf16 v[24:39], v[72:75], v[84:87], 0
    ds_read_b64_tr_b16 v[92:93], v3 offset:2048
    s_add_u32 m0, s14, 7168
    s_add_u32 s12, s12, 28672
    s_setprio 0
    buffer_load_dwordx4 v1, s[60:63], s12 offen lds
    s_setprio 3
    s_waitcnt lgkmcnt(1)
    v_mfma_f32_32x32x16_bf16 v[40:55], v[76:79], v[80:83], 0
    ds_read_b64_tr_b16 v[94:95], v3 offset:2560
    s_add_u32 m0, s14, 8192
    s_add_u32 s12, s12, 28672
    s_setprio 0
    buffer_load_dwordx4 v1, s[60:63], s12 offen lds
    s_setprio 3
    s_waitcnt lgkmcnt(1)
    v_mfma_f32_32x32x16_bf16 v[56:71], v[76:79], v[84:87], 0
    ds_read_b128 v[96:99], v4 offset:1056
    ds_read_b128 v[100:103], v7 offset:1056
    s_add_u32 m0, s14, 9216
    s_add_u32 s12, s12, 28672
    s_setprio 0
    buffer_load_dwordx4 v1, s[60:63], s12 offen lds
    s_setprio 3
    s_waitcnt vmcnt(4)
    s_waitcnt lgkmcnt(0)
    v_mfma_f32_32x32x16_bf16 v[8:23], v[88:91], v[96:99], v[8:23]
    ds_read_b64_tr_b16 v[104:105], v2 offset:4096
    ds_read_b64_tr_b16 v[106:107], v2 offset:4608
    s_add_u32 m0, s14, 10240
    s_add_u32 s12, s12, 28672
    s_setprio 0
    buffer_load_dwordx4 v1, s[60:63], s12 offen lds
    s_setprio 3
    s_waitcnt lgkmcnt(1)
    v_mfma_f32_32x32x16_bf16 v[24:39], v[88:91], v[100:103], v[24:39]
    ds_read_b64_tr_b16 v[108:109], v3 offset:4096
    s_add_u32 m0, s14, 11264
    s_add_u32 s12, s12, 28672
    s_setprio 0
    buffer_load_dwordx4 v1, s[60:63], s12 offen lds
    s_setprio 3
    s_waitcnt lgkmcnt(1)
    v_mfma_f32_32x32x16_bf16 v[40:55], v[92:95], v[96:99], v[40:55]
    ds_read_b64_tr_b16 v[110:111], v3 offset:4608
    s_add_u32 m0, s14, 12288
    s_add_u32 s12, s12, 28672
    s_setprio 0
    buffer_load_dwordx4 v1, s[60:63], s12 offen lds
    s_setprio 3
    s_waitcnt lgkmcnt(1)
    v_mfma_f32_32x32x16_bf16 v[56:71], v[92:95], v[100:103], v[56:71]
    ds_read_b128 v[112:115], v4 offset:2112
    ds_read_b128 v[116:119], v7 offset:2112
    s_add_u32 m0, s14, 13312
    s_add_u32 s12, s12, 28672
    s_setprio 0
    buffer_load_dwordx4 v1, s[60:63], s12 offen lds
    s_setprio 3
    s_waitcnt vmcnt(6)
    s_waitcnt lgkmcnt(0)
    v_mfma_f32_32x32x16_bf16 v[8:23], v[104:107], v[112:115], v[8:23]
    ds_read_b64_tr_b16 v[72:73], v2 offset:6144
    ds_read_b64_tr_b16 v[74:75], v2 offset:6656
    s_waitcnt lgkmcnt(1)
    v_mfma_f32_32x32x16_bf16 v[24:39], v[104:107], v[116:119], v[24:39]
    ds_read_b64_tr_b16 v[76:77], v3 offset:6144
    s_waitcnt lgkmcnt(1)
    v_mfma_f32_32x32x16_bf16 v[40:55], v[108:111], v[112:115], v[40:55]
    ds_read_b64_tr_b16 v[78:79], v3 offset:6656
    s_add_u32 m0, s14, 14336
    s_add_u32 s12, s12, 28672
    s_setprio 0
    buffer_load_dwordx4 v1, s[60:63], s12 offen lds
    s_setprio 3
    s_waitcnt lgkmcnt(1)
    v_mfma_f32_32x32x16_bf16 v[56:71], v[108:111], v[116:119], v[56:71]
    ds_read_b128 v[80:83], v4 offset:3168
    ds_read_b128 v[84:87], v7 offset:3168
    s_add_u32 m0, s14, 15360
    s_add_u32 s12, s12, 28672
    s_setprio 0
    buffer_load_dwordx4 v1, s[60:63], s12 offen lds
    s_setprio 3
    s_waitcnt vmcnt(6)
    s_waitcnt lgkmcnt(0)
    v_mfma_f32_32x32x16_bf16 v[8:23], v[72:75], v[80:83], v[8:23]
    ds_read_b64_tr_b16 v[88:89], v2 offset:8192
    ds_read_b64_tr_b16 v[90:91], v2 offset:8704
    s_waitcnt lgkmcnt(1)
    v_mfma_f32_32x32x16_bf16 v[24:39], v[72:75], v[84:87], v[24:39]
    ds_read_b64_tr_b16 v[92:93], v3 offset:8192
    s_waitcnt lgkmcnt(1)
    v_mfma_f32_32x32x16_bf16 v[40:55], v[76:79], v[80:83], v[40:55]
    ds_read_b64_tr_b16 v[94:95], v3 offset:8704
    s_cmp_eq_u32 s11, 3
    s_cselect_b32 s9, 1835008, 0
    s_sub_u32 s12, s12, s9
    s_add_u32 m0, s14, 16384
    s_add_u32 s12, s12, 28672
    s_setprio 0
    buffer_load_dwordx4 v1, s[60:63], s12 offen lds
    s_setprio 3
    s_waitcnt lgkmcnt(1)
    v_mfma_f32_32x32x16_bf16 v[56:71], v[76:79], v[84:87], v[56:71]
    ds_read_b128 v[96:99], v4 offset:4224
    ds_read_b128 v[100:103], v7 offset:4224
    s_add_u32 m0, s14, 17408
    s_add_u32 s12, s12, 28672
    s_setprio 0
    buffer_load_dwordx4 v1, s[60:63], s12 offen lds
    s_setprio 3
    s_waitcnt vmcnt(6)
    s_waitcnt lgkmcnt(0)
    v_mfma_f32_32x32x16_bf16 v[8:23], v[88:91], v[96:99], v[8:23]
    ds_read_b64_tr_b16 v[104:105], v2 offset:10240
    ds_read_b64_tr_b16 v[106:107], v2 offset:10752
    s_waitcnt lgkmcnt(1)
    v_mfma_f32_32x32x16_bf16 v[24:39], v[88:91], v[100:103], v[24:39]
    ds_read_b64_tr_b16 v[108:109], v3 offset:10240
    s_waitcnt lgkmcnt(1)
    v_mfma_f32_32x32x16_bf16 v[40:55], v[92:95], v[96:99], v[40:55]
    ds_read_b64_tr_b16 v[110:111], v3 offset:10752
    s_add_u32 m0, s14, 18432
    s_add_u32 s12, s12, 28672
    s_setprio 0
    buffer_load_dwordx4 v1, s[60:63], s12 offen lds
    s_setprio 3
    s_waitcnt lgkmcnt(1)
    v_mfma_f32_32x32x16_bf16 v[56:71], v[92:95], v[100:103], v[56:71]
    ds_read_b128 v[112:115], v4 offset:5280
    ds_read_b128 v[116:119], v7 offset:5280
    s_add_u32 m0, s14, 19456
    s_add_u32 s12, s12, 28672
    s_setprio 0
    buffer_load_dwordx4 v1, s[60:63], s12 offen lds
    s_setprio 3
    s_cmp_lg_u32 s10, 1
    s_cbranch_scc1 L_notouch_49
    v_min_u32 v136, 55, v0
    v_lshlrev_b32 v136, 7, v136
    s_mul_i32 s6, s42, 7168
    buffer_load_dword v6, v136, s[52:55], s6 offen
L_notouch_49:
    s_cmp_lg_u32 s10, 2
    s_cbranch_scc1 L_notouch_50
    v_min_u32 v136, 15, v0
    v_lshlrev_b32 v136, 7, v136
    s_mul_i32 s6, s42, 2048
    buffer_load_dword v6, v136, s[56:59], s6 offen
L_notouch_50:
    s_waitcnt vmcnt(6)
    s_waitcnt lgkmcnt(0)
    v_mfma_f32_32x32x16_bf16 v[8:23], v[104:107], v[112:115], v[8:23]
    ds_read_b64_tr_b16 v[72:73], v2 offset:12288
    ds_read_b64_tr_b16 v[74:75], v2 offset:12800
    s_waitcnt lgkmcnt(1)
    v_mfma_f32_32x32x16_bf16 v[24:39], v[104:107], v[116:119], v[24:39]
    ds_read_b64_tr_b16 v[76:77], v3 offset:12288
    s_waitcnt lgkmcnt(1)
    v_mfma_f32_32x32x16_bf16 v[40:55], v[108:111], v[112:115], v[40:55]
    ds_read_b64_tr_b16 v[78:79], v3 offset:12800
    s_add_u32 m0, s14, 0
    s_add_u32 s12, s12, 28672
    s_setprio 0
    buffer_load_dwordx4 v1, s[60:63], s12 offen lds
    s_setprio 3
    s_waitcnt lgkmcnt(1)
    v_mfma_f32_32x32x16_bf16 v[56:71], v[108:111], v[116:119], v[56:71]
    ds_read_b128 v[80:83], v4 offset:6336
    ds_read_b128 v[84:87], v7 offset:6336
    s_add_u32 m0, s14, 1024
    s_add_u32 s12, s12, 28672
    s_setprio 0
    buffer_load_dwordx4 v1, s[60:63], s12 offen lds
    s_setprio 3
    s_waitcnt vmcnt(6)
    s_waitcnt lgkmcnt(0)
    v_mfma_f32_32x32x16_bf16 v[8:23], v[72:75], v[80:83], v[8:23]
    ds_read_b64_tr_b16 v[88:89], v2 offset:14336
    ds_read_b64_tr_b16 v[90:91], v2 offset:14848
    s_waitcnt lgkmcnt(1)
    v_mfma_f32_32x32x16_bf16 v[24:39], v[72:75], v[84:87], v[24:39]
    ds_read_b64_tr_b16 v[92:93], v3 offset:14336
    s_waitcnt lgkmcnt(1)
    v_mfma_f32_32x32x16_bf16 v[40:55], v[76:79], v[80:83], v[40:55]
    ds_read_b64_tr_b16 v[94:95], v3 offset:14848
    s_add_u32 m0, s14, 2048
    s_add_u32 s12, s12, 28672
    s_setprio 0
    buffer_load_dwordx4 v1, s[60:63], s12 offen lds
    s_setprio 3
    s_waitcnt lgkmcnt(1)
    v_mfma_f32_32x32x16_bf16 v[56:71], v[76:79], v[84:87], v[56:71]
    ds_read_b128 v[96:99], v4 offset:7392
    ds_read_b128 v[100:103], v7 offset:7392
    s_add_u32 m0, s14, 3072
    s_add_u32 s12, s12, 28672
    s_setprio 0
    buffer_load_dwordx4 v1, s[60:63], s12 offen lds
    s_setprio 3
    s_add_u32 s6, s11, 1
    s_and_b32 s6, s6, 3
    s_mul_i32 s6, s6, 8448
    s_add_u32 s7, s6, 33792
    v_add_u32 v4, s6, v158
    v_add_u32 v7, s7, v158
    s_waitcnt vmcnt(6)
    s_waitcnt lgkmcnt(0)
    v_mfma_f32_32x32x16_bf16 v[8:23], v[88:91], v[96:99], v[8:23]
    ds_read_b64_tr_b16 v[104:105], v2 offset:16384
    ds_read_b64_tr_b16 v[106:107], v2 offset:16896
    s_waitcnt lgkmcnt(1)
    v_mfma_f32_32x32x16_bf16 v[24:39], v[88:91], v[100:103], v[24:39]
    ds_read_b64_tr_b16 v[108:109], v3 offset:16384
    s_waitcnt lgkmcnt(1)
    v_mfma_f32_32x32x16_bf16 v[40:55], v[92:95], v[96:99], v[40:55]
    ds_read_b64_tr_b16 v[110:111], v3 offset:16896
    s_add_u32 m0, s14, 4096
    s_add_u32 s12, s12, 28672
    s_setprio 0
    buffer_load_dwordx4 v1, s[60:63], s12 offen lds
    s_setprio 3
    s_waitcnt lgkmcnt(1)
    v_mfma_f32_32x32x16_bf16 v[56:71], v[92:95], v[100:103], v[56:71]
    ds_read_b128 v[112:115], v4 offset:0
    ds_read_b128 v[116:119], v7 offset:0
    s_add_u32 m0, s14, 5120
    s_add_u32 s12, s12, 28672
    s_setprio 0
    buffer_load_dwordx4 v1, s[60:63], s12 offen lds
    s_setprio 3
    s_waitcnt vmcnt(6)
    s_waitcnt lgkmcnt(0)
    v_mfma_f32_32x32x16_bf16 v[8:23], v[104:107], v[112:115], v[8:23]
    ds_read_b64_tr_b16 v[72:73], v2 offset:18432
    ds_read_b64_tr_b16 v[74:75], v2 offset:18944
    s_waitcnt lgkmcnt(1)
    v_mfma_f32_32x32x16_bf16 v[24:39], v[104:107], v[116:119], v[24:39]
    ds_read_b64_tr_b16 v[76:77], v3 offset:18432
    s_waitcnt lgkmcnt(1)
    v_mfma_f32_32x32x16_bf16 v[40:55], v[108:111], v[112:115], v[40:55]
    ds_read_b64_tr_b16 v[78:79], v3 offset:18944
    s_add_u32 m0, s14, 6144
    s_add_u32 s12, s12, 28672
    s_setprio 0
    buffer_load_dwordx4 v1, s[60:63], s12 offen lds
    s_setprio 3
    s_waitcnt lgkmcnt(1)
    v_mfma_f32_32x32x16_bf16 v[56:71], v[108:111], v[116:119], v[56:71]
    ds_read_b128 v[80:83], v4 offset:1056
    ds_read_b128 v[84:87], v7 offset:1056
    s_add_u32 m0, s14, 7168
    s_add_u32 s12, s12, 28672
    s_setprio 0
    buffer_load_dwordx4 v1, s[60:63], s12 offen lds
    s_setprio 3
    s_waitcnt vmcnt(6)
    s_waitcnt lgkmcnt(0)
    v_mfma_f32_32x32x16_bf16 v[8:23], v[72:75], v[80:83], v[8:23]
    ds_read_b64_tr_b16 v[88:89], v2 offset:0
    ds_read_b64_tr_b16 v[90:91], v2 offset:512
    s_waitcnt lgkmcnt(1)
    v_mfma_f32_32x32x16_bf16 v[24:39], v[72:75], v[84:87], v[24:39]
    ds_read_b64_tr_b16 v[92:93], v3 offset:0
    s_waitcnt lgkmcnt(1)
    v_mfma_f32_32x32x16_bf16 v[40:55], v[76:79], v[80:83], v[40:55]
    ds_read_b64_tr_b16 v[94:95], v3 offset:512
    s_add_u32 m0, s14, 8192
    s_add_u32 s12, s12, 28672
    s_setprio 0
    buffer_load_dwordx4 v1, s[60:63], s12 offen lds
    s_setprio 3
    s_waitcnt lgkmcnt(1)
    v_mfma_f32_32x32x16_bf16 v[56:71], v[76:79], v[84:87], v[56:71]
    ds_read_b128 v[96:99], v4 offset:2112
    ds_read_b128 v[100:103], v7 offset:2112
    s_add_u32 m0, s14, 9216
    s_add_u32 s12, s12, 28672
    s_setprio 0
    buffer_load_dwordx4 v1, s[60:63], s12 offen lds
    s_setprio 3
    s_waitcnt vmcnt(6)
    s_waitcnt lgkmcnt(0)
    v_mfma_f32_32x32x16_bf16 v[8:23], v[88:91], v[96:99], v[8:23]
    ds_read_b64_tr_b16 v[104:105], v2 offset:2048
    ds_read_b64_tr_b16 v[106:107], v2 offset:2560
    s_waitcnt lgkmcnt(1)
    v_mfma_f32_32x32x16_bf16 v[24:39], v[88:91], v[100:103], v[24:39]
    ds_read_b64_tr_b16 v[108:109], v3 offset:2048
    s_waitcnt lgkmcnt(1)
    v_mfma_f32_32x32x16_bf16 v[40:55], v[92:95], v[96:99], v[40:55]
    ds_read_b64_tr_b16 v[110:111], v3 offset:2560
    s_add_u32 m0, s14, 10240
    s_add_u32 s12, s12, 28672
    s_setprio 0
    buffer_load_dwordx4 v1, s[60:63], s12 offen lds
    s_setprio 3
    s_waitcnt lgkmcnt(1)
    v_mfma_f32_32x32x16_bf16 v[56:71], v[92:95], v[100:103], v[56:71]
    ds_read_b128 v[112:115], v4 offset:3168
    ds_read_b128 v[116:119], v7 offset:3168
    s_add_u32 m0, s14, 11264
    s_add_u32 s12, s12, 28672
    s_setprio 0
    buffer_load_dwordx4 v1, s[60:63], s12 offen lds
    s_setprio 3
    s_waitcnt vmcnt(6)
    s_waitcnt lgkmcnt(0)
    v_mfma_f32_32x32x16_bf16 v[8:23], v[104:107], v[112:115], v[8:23]
    ds_read_b64_tr_b16 v[72:73], v2 offset:4096
    ds_read_b64_tr_b16 v[74:75], v2 offset:4608
    s_waitcnt lgkmcnt(1)
    v_mfma_f32_32x32x16_bf16 v[24:39], v[104:107], v[116:119], v[24:39]
    ds_read_b64_tr_b16 v[76:77], v3 offset:4096
    s_waitcnt lgkmcnt(1)
    v_mfma_f32_32x32x16_bf16 v[40:55], v[108:111], v[112:115], v[40:55]
    ds_read_b64_tr_b16 v[78:79], v3 offset:4608
    s_cmp_eq_u32 s11, 2
    s_cselect_b32 s9, 1835008, 0
    s_sub_u32 s12, s12, s9
    s_add_u32 m0, s14, 12288
    s_add_u32 s12, s12, 28672
    s_setprio 0
    buffer_load_dwordx4 v1, s[60:63], s12 offen lds
    s_setprio 3
    s_waitcnt lgkmcnt(1)
    v_mfma_f32_32x32x16_bf16 v[56:71], v[108:111], v[116:119], v[56:71]
    ds_read_b128 v[80:83], v4 offset:4224
    ds_read_b128 v[84:87], v7 offset:4224
    s_add_u32 m0, s14, 13312
    s_add_u32 s12, s12, 28672
    s_setprio 0
    buffer_load_dwordx4 v1, s[60:63], s12 offen lds
    s_setprio 3
    s_waitcnt vmcnt(6)
    s_waitcnt lgkmcnt(0)
    v_mfma_f32_32x32x16_bf16 v[8:23], v[72:75], v[80:83], v[8:23]
    ds_read_b64_tr_b16 v[88:89], v2 offset:6144
    ds_read_b64_tr_b16 v[90:91], v2 offset:6656
    s_waitcnt lgkmcnt(1)
    v_mfma_f32_32x32x16_bf16 v[24:39], v[72:75], v[84:87], v[24:39]
    ds_read_b64_tr_b16 v[92:93], v3 offset:6144
    s_waitcnt lgkmcnt(1)
    v_mfma_f32_32x32x16_bf16 v[40:55], v[76:79], v[80:83], v[40:55]
    ds_read_b64_tr_b16 v[94:95], v3 offset:6656
    s_add_u32 m0, s14, 14336
    s_add_u32 s12, s12, 28672
    s_setprio 0
    buffer_load_dwordx4 v1, s[60:63], s12 offen lds
    s_setprio 3
    s_waitcnt lgkmcnt(1)
    v_mfma_f32_32x32x16_bf16 v[56:71], v[76:79], v[84:87], v[56:71]
    ds_read_b128 v[96:99], v4 offset:5280
    ds_read_b128 v[100:103], v7 offset:5280
    s_add_u32 m0, s14, 15360
    s_add_u32 s12, s12, 28672
    s_setprio 0
    buffer_load_dwordx4 v1, s[60:63], s12 offen lds
    s_setprio 3
    s_waitcnt vmcnt(6)
    s_waitcnt lgkmcnt(0)
    v_mfma_f32_32x32x16_bf16 v[8:23], v[88:91], v[96:99], v[8:23]
    ds_read_b64_tr_b16 v[104:105], v2 offset:8192
    ds_read_b64_tr_b16 v[106:107], v2 offset:8704
    s_waitcnt lgkmcnt(1)
    v_mfma_f32_32x32x16_bf16 v[24:39], v[88:91], v[100:103], v[24:39]
    ds_read_b64_tr_b16 v[108:109], v3 offset:8192
    s_waitcnt lgkmcnt(1)
    v_mfma_f32_32x32x16_bf16 v[40:55], v[92:95], v[96:99], v[40:55]
    ds_read_b64_tr_b16 v[110:111], v3 offset:8704
    s_add_u32 m0, s14, 16384
    s_add_u32 s12, s12, 28672
    s_setprio 0
    buffer_load_dwordx4 v1, s[60:63], s12 offen lds
    s_setprio 3
    s_waitcnt lgkmcnt(1)
    v_mfma_f32_32x32x16_bf16 v[56:71], v[92:95], v[100:103], v[56:71]
    ds_read_b128 v[112:115], v4 offset:6336
    ds_read_b128 v[116:119], v7 offset:6336
    s_add_u32 m0, s14, 17408
    s_add_u32 s12, s12, 28672
    s_setprio 0
    buffer_load_dwordx4 v1, s[60:63], s12 offen lds
    s_setprio 3
    s_waitcnt vmcnt(6)
    s_waitcnt lgkmcnt(0)
    v_mfma_f32_32x32x16_bf16 v[8:23], v[104:107], v[112:115], v[8:23]
    ds_read_b64_tr_b16 v[72:73], v2 offset:10240
    ds_read_b64_tr_b16 v[74:75], v2 offset:10752
    s_waitcnt lgkmcnt(1)
    v_mfma_f32_32x32x16_bf16 v[24:39], v[104:107], v[116:119], v[24:39]
    ds_read_b64_tr_b16 v[76:77], v3 offset:10240
    s_waitcnt lgkmcnt(1)
    v_mfma_f32_32x32x16_bf16 v[40:55], v[108:111], v[112:115], v[40:55]
    ds_read_b64_tr_b16 v[78:79], v3 offset:10752
    s_add_u32 m0, s14, 18432
    s_add_u32 s12, s12, 28672
    s_setprio 0
    buffer_load_dwordx4 v1, s[60:63], s12 offen lds
    s_setprio 3
    s_waitcnt lgkmcnt(1)
    v_mfma_f32_32x32x16_bf16 v[56:71], v[108:111], v[116:119], v[56:71]
    ds_read_b128 v[80:83], v4 offset:7392
    ds_read_b128 v[84:87], v7 offset:7392
    s_add_u32 m0, s14, 19456
    s_add_u32 s12, s12, 28672
    s_setprio 0
    buffer_load_dwordx4 v1, s[60:63], s12 offen lds
    s_setprio 3
    s_add_u32 s6, s11, 2
    s_and_b32 s6, s6, 3
    s_mul_i32 s6, s6, 8448
    s_add_u32 s7, s6, 33792
    v_add_u32 v4, s6, v158
    v_add_u32 v7, s7, v158
    s_waitcnt vmcnt(6)
    s_waitcnt lgkmcnt(0)
    v_mfma_f32_32x32x16_bf16 v[8:23], v[72:75], v[80:83], v[8:23]
    ds_read_b64_tr_b16 v[88:89], v2 offset:12288
    ds_read_b64_tr_b16 v[90:91], v2 offset:12800
    s_waitcnt lgkmcnt(1)
    v_mfma_f32_32x32x16_bf16 v[24:39], v[72:75], v[84:87], v[24:39]
    ds_read_b64_tr_b16 v[92:93], v3 offset:12288
    s_waitcnt lgkmcnt(1)
    v_mfma_f32_32x32x16_bf16 v[40:55], v[76:79], v[80:83], v[40:55]
    ds_read_b64_tr_b16 v[94:95], v3 offset:12800
    s_add_u32 m0, s14, 0
    s_add_u32 s12, s12, 28672
    s_setprio 0
    buffer_load_dwordx4 v1, s[60:63], s12 offen lds
    s_setprio 3
    s_waitcnt lgkmcnt(1)
    v_mfma_f32_32x32x16_bf16 v[56:71], v[76:79], v[84:87], v[56:71]
    ds_read_b128 v[96:99], v4 offset:0
    ds_read_b128 v[100:103], v7 offset:0
    s_add_u32 m0, s14, 1024
    s_add_u32 s12, s12, 28672
    s_setprio 0
    buffer_load_dwordx4 v1, s[60:63], s12 offen lds
    s_setprio 3
    s_waitcnt vmcnt(6)
    s_waitcnt lgkmcnt(0)
    v_mfma_f32_32x32x16_bf16 v[8:23], v[88:91], v[96:99], v[8:23]
    ds_read_b64_tr_b16 v[104:105], v2 offset:14336
    ds_read_b64_tr_b16 v[106:107], v2 offset:14848
    s_waitcnt lgkmcnt(1)
    v_mfma_f32_32x32x16_bf16 v[24:39], v[88:91], v[100:103], v[24:39]
    ds_read_b64_tr_b16 v[108:109], v3 offset:14336
    s_waitcnt lgkmcnt(1)
    v_mfma_f32_32x32x16_bf16 v[40:55], v[92:95], v[96:99], v[40:55]
    ds_read_b64_tr_b16 v[110:111], v3 offset:14848
    s_add_u32 m0, s14, 2048
    s_add_u32 s12, s12, 28672
    s_setprio 0
    buffer_load_dwordx4 v1, s[60:63], s12 offen lds
    s_setprio 3
    s_waitcnt lgkmcnt(1)
    v_mfma_f32_32x32x16_bf16 v[56:71], v[92:95], v[100:103], v[56:71]
    ds_read_b128 v[112:115], v4 offset:1056
    ds_read_b128 v[116:119], v7 offset:1056
    s_add_u32 m0, s14, 3072
    s_add_u32 s12, s12, 28672
    s_setprio 0
    buffer_load_dwordx4 v1, s[60:63], s12 offen lds
    s_setprio 3
    s_waitcnt vmcnt(6)
    s_waitcnt lgkmcnt(0)
    v_mfma_f32_32x32x16_bf16 v[8:23], v[104:107], v[112:115], v[8:23]
    ds_read_b64_tr_b16 v[72:73], v2 offset:16384
    ds_read_b64_tr_b16 v[74:75], v2 offset:16896
    s_waitcnt lgkmcnt(1)
    v_mfma_f32_32x32x16_bf16 v[24:39], v[104:107], v[116:119], v[24:39]
    ds_read_b64_tr_b16 v[76:77], v3 offset:16384
    s_waitcnt lgkmcnt(1)
    v_mfma_f32_32x32x16_bf16 v[40:55], v[108:111], v[112:115], v[40:55]
    ds_read_b64_tr_b16 v[78:79], v3 offset:16896
    s_add_u32 m0, s14, 4096
    s_add_u32 s12, s12, 28672
    s_setprio 0
    buffer_load_dwordx4 v1, s[60:63], s12 offen lds
    s_setprio 3
    s_waitcnt lgkmcnt(1)
    v_mfma_f32_32x32x16_bf16 v[56:71], v[108:111], v[116:119], v[56:71]
    ds_read_b128 v[80:83], v4 offset:2112
    ds_read_b128 v[84:87], v7 offset:2112
    s_add_u32 m0, s14, 5120
    s_add_u32 s12, s12, 28672
    s_setprio 0
    buffer_load_dwordx4 v1, s[60:63], s12 offen lds
    s_setprio 3
    s_waitcnt vmcnt(6)
    s_waitcnt lgkmcnt(0)
    v_mfma_f32_32x32x16_bf16 v[8:23], v[72:75], v[80:83], v[8:23]
    ds_read_b64_tr_b16 v[88:89], v2 offset:18432
    ds_read_b64_tr_b16 v[90:91], v2 offset:18944
    s_waitcnt lgkmcnt(1)
    v_mfma_f32_32x32x16_bf16 v[24:39], v[72:75], v[84:87], v[24:39]
    ds_read_b64_tr_b16 v[92:93], v3 offset:18432
    s_waitcnt lgkmcnt(1)
    v_mfma_f32_32x32x16_bf16 v[40:55], v[76:79], v[80:83], v[40:55]
    ds_read_b64_tr_b16 v[94:95], v3 offset:18944
    s_add_u32 m0, s14, 6144
    s_add_u32 s12, s12, 28672
    s_setprio 0
    buffer_load_dwordx4 v1, s[60:63], s12 offen lds
    s_setprio 3
    s_waitcnt lgkmcnt(1)
    v_mfma_f32_32x32x16_bf16 v[56:71], v[76:79], v[84:87], v[56:71]
    ds_read_b128 v[96:99], v4 offset:3168
    ds_read_b128 v[100:103], v7 offset:3168
    s_add_u32 m0, s14, 7168
    s_add_u32 s12, s12, 28672
    s_setprio 0
    buffer_load_dwordx4 v1, s[60:63], s12 offen lds
    s_setprio 3
    s_waitcnt vmcnt(6)
    s_waitcnt lgkmcnt(0)
    v_mfma_f32_32x32x16_bf16 v[8:23], v[88:91], v[96:99], v[8:23]
    ds_read_b64_tr_b16 v[104:105], v2 offset:0
    ds_read_b64_tr_b16 v[106:107], v2 offset:512
    s_waitcnt lgkmcnt(1)
    v_mfma_f32_32x32x16_bf16 v[24:39], v[88:91], v[100:103], v[24:39]
    ds_read_b64_tr_b16 v[108:109], v3 offset:0
    s_waitcnt lgkmcnt(1)
    v_mfma_f32_32x32x16_bf16 v[40:55], v[92:95], v[96:99], v[40:55]
    ds_read_b64_tr_b16 v[110:111], v3 offset:512
    s_cmp_eq_u32 s11, 1
    s_cselect_b32 s9, 1835008, 0
    s_sub_u32 s12, s12, s9
    s_add_u32 m0, s14, 8192
    s_add_u32 s12, s12, 28672
    s_setprio 0
    buffer_load_dwordx4 v1, s[60:63], s12 offen lds
    s_setprio 3
    s_waitcnt lgkmcnt(1)
    v_mfma_f32_32x32x16_bf16 v[56:71], v[92:95], v[100:103], v[56:71]
    ds_read_b128 v[112:115], v4 offset:4224
    ds_read_b128 v[116:119], v7 offset:4224
    s_add_u32 m0, s14, 9216
    s_add_u32 s12, s12, 28672
    s_setprio 0
    buffer_load_dwordx4 v1, s[60:63], s12 offen lds
    s_setprio 3
    s_waitcnt vmcnt(6)
    s_waitcnt lgkmcnt(0)
    v_mfma_f32_32x32x16_bf16 v[8:23], v[104:107], v[112:115], v[8:23]
    ds_read_b64_tr_b16 v[72:73], v2 offset:2048
    ds_read_b64_tr_b16 v[74:75], v2 offset:2560
    s_waitcnt lgkmcnt(1)
    v_mfma_f32_32x32x16_bf16 v[24:39], v[104:107], v[116:119], v[24:39]
    ds_read_b64_tr_b16 v[76:77], v3 offset:2048
    s_waitcnt lgkmcnt(1)
    v_mfma_f32_32x32x16_bf16 v[40:55], v[108:111], v[112:115], v[40:55]
    ds_read_b64_tr_b16 v[78:79], v3 offset:2560
    s_add_u32 m0, s14, 10240
    s_add_u32 s12, s12, 28672
    s_setprio 0
    buffer_load_dwordx4 v1, s[60:63], s12 offen lds
    s_setprio 3
    s_waitcnt lgkmcnt(1)
    v_mfma_f32_32x32x16_bf16 v[56:71], v[108:111], v[116:119], v[56:71]
    ds_read_b128 v[80:83], v4 offset:5280
    ds_read_b128 v[84:87], v7 offset:5280
    s_add_u32 m0, s14, 11264
    s_add_u32 s12, s12, 28672
    s_setprio 0
    buffer_load_dwordx4 v1, s[60:63], s12 offen lds
    s_setprio 3
    s_lshl_b32 s6, s5, 6
    s_lshl2_add_u32 s6, s4, s6
    s_add_u32 s6, s6, s10
    s_lshl_b32 s6, s6, 10
    s_add_u32 s6, s6, 3145728
    s_add_u32 s7, s6, 32768
    v_mov_b32 v140, -1
    v_mov_b32 v141, -1
    v_mov_b32 v142, -1
    v_mov_b32 v143, -1
    s_cmp_lg_u32 s70, 0
    s_cbranch_scc0 L_thr_51
    buffer_store_dwordx4 v[140:143], v161, s[48:51], s6 offen
    s_branch L_std_52
L_thr_51:
    buffer_store_dwordx4 v[140:143], v161, s[48:51], s6 offen sc1
L_std_52:
    s_cmp_lg_u32 s70, 0
    s_cbranch_scc0 L_thr_53
    buffer_store_dwordx4 v[140:143], v161, s[48:51], s7 offen
    s_branch L_std_54
L_thr_53:
    buffer_store_dwordx4 v[140:143], v161, s[48:51], s7 offen sc1
L_std_54:
    s_waitcnt vmcnt(8)
    s_waitcnt lgkmcnt(0)
    v_mfma_f32_32x32x16_bf16 v[8:23], v[72:75], v[80:83], v[8:23]
    ds_read_b64_tr_b16 v[88:89], v2 offset:4096
    ds_read_b64_tr_b16 v[90:91], v2 offset:4608
    s_waitcnt lgkmcnt(1)
    v_mfma_f32_32x32x16_bf16 v[24:39], v[72:75], v[84:87], v[24:39]
    ds_read_b64_tr_b16 v[92:93], v3 offset:4096
    s_waitcnt lgkmcnt(1)
    v_mfma_f32_32x32x16_bf16 v[40:55], v[76:79], v[80:83], v[40:55]
    ds_read_b64_tr_b16 v[94:95], v3 offset:4608
    s_add_u32 m0, s14, 12288
    s_add_u32 s12, s12, 28672
    s_setprio 0
    buffer_load_dwordx4 v1, s[60:63], s12 offen lds
    s_setprio 3
    s_waitcnt lgkmcnt(1)
    v_mfma_f32_32x32x16_bf16 v[56:71], v[76:79], v[84:87], v[56:71]
    ds_read_b128 v[96:99], v4 offset:6336
    ds_read_b128 v[100:103], v7 offset:6336
    s_add_u32 m0, s14, 13312
    s_add_u32 s12, s12, 28672
    s_setprio 0
    buffer_load_dwordx4 v1, s[60:63], s12 offen lds
    s_setprio 3
    s_waitcnt vmcnt(8)
    s_waitcnt lgkmcnt(0)
    v_mfma_f32_32x32x16_bf16 v[8:23], v[88:91], v[96:99], v[8:23]
    ds_read_b64_tr_b16 v[104:105], v2 offset:6144
    ds_read_b64_tr_b16 v[106:107], v2 offset:6656
    s_waitcnt lgkmcnt(1)
    v_mfma_f32_32x32x16_bf16 v[24:39], v[88:91], v[100:103], v[24:39]
    ds_read_b64_tr_b16 v[108:109], v3 offset:6144
    s_waitcnt lgkmcnt(1)
    v_mfma_f32_32x32x16_bf16 v[40:55], v[92:95], v[96:99], v[40:55]
    ds_read_b64_tr_b16 v[110:111], v3 offset:6656
    s_add_u32 m0, s14, 14336
    s_add_u32 s12, s12, 28672
    s_setprio 0
    buffer_load_dwordx4 v1, s[60:63], s12 offen lds
    s_setprio 3
    s_waitcnt lgkmcnt(1)
    v_mfma_f32_32x32x16_bf16 v[56:71], v[92:95], v[100:103], v[56:71]
    ds_read_b128 v[112:115], v4 offset:7392
    ds_read_b128 v[116:119], v7 offset:7392
    s_add_u32 m0, s14, 15360
    s_add_u32 s12, s12, 28672
    s_setprio 0
    buffer_load_dwordx4 v1, s[60:63], s12 offen lds
    s_setprio 3
    s_add_u32 s6, s11, 3
    s_and_b32 s6, s6, 3
    s_mul_i32 s6, s6, 8448
    s_add_u32 s7, s6, 33792
    v_add_u32 v4, s6, v158
    v_add_u32 v7, s7, v158
    s_waitcnt vmcnt(8)
    s_waitcnt lgkmcnt(0)
    v_mfma_f32_32x32x16_bf16 v[8:23], v[104:107], v[112:115], v[8:23]
    ds_read_b64_tr_b16 v[72:73], v2 offset:8192
    ds_read_b64_tr_b16 v[74:75], v2 offset:8704
    s_waitcnt lgkmcnt(1)
    v_mfma_f32_32x32x16_bf16 v[24:39], v[104:107], v[116:119], v[24:39]
    ds_read_b64_tr_b16 v[76:77], v3 offset:8192
    s_waitcnt lgkmcnt(1)
    v_mfma_f32_32x32x16_bf16 v[40:55], v[108:111], v[112:115], v[40:55]
    ds_read_b64_tr_b16 v[78:79], v3 offset:8704
    s_add_u32 m0, s14, 16384
    s_add_u32 s12, s12, 28672
    s_setprio 0
    buffer_load_dwordx4 v1, s[60:63], s12 offen lds
    s_setprio 3
    s_waitcnt lgkmcnt(1)
    v_mfma_f32_32x32x16_bf16 v[56:71], v[108:111], v[116:119], v[56:71]
    ds_read_b128 v[80:83], v4 offset:0
    ds_read_b128 v[84:87], v7 offset:0
    s_add_u32 m0, s14, 17408
    s_add_u32 s12, s12, 28672
    s_setprio 0
    buffer_load_dwordx4 v1, s[60:63], s12 offen lds
    s_setprio 3
    s_waitcnt vmcnt(8)
    s_waitcnt lgkmcnt(0)
    v_mfma_f32_32x32x16_bf16 v[8:23], v[72:75], v[80:83], v[8:23]
    ds_read_b64_tr_b16 v[88:89], v2 offset:10240
    ds_read_b64_tr_b16 v[90:91], v2 offset:10752
    s_waitcnt lgkmcnt(1)
    v_mfma_f32_32x32x16_bf16 v[24:39], v[72:75], v[84:87], v[24:39]
    ds_read_b64_tr_b16 v[92:93], v3 offset:10240
    s_waitcnt lgkmcnt(1)
    v_mfma_f32_32x32x16_bf16 v[40:55], v[76:79], v[80:83], v[40:55]
    ds_read_b64_tr_b16 v[94:95], v3 offset:10752
    s_add_u32 m0, s14, 18432
    s_add_u32 s12, s12, 28672
    s_setprio 0
    buffer_load_dwordx4 v1, s[60:63], s12 offen lds
    s_setprio 3
    s_waitcnt lgkmcnt(1)
    v_mfma_f32_32x32x16_bf16 v[56:71], v[76:79], v[84:87], v[56:71]
    ds_read_b128 v[96:99], v4 offset:1056
    ds_read_b128 v[100:103], v7 offset:1056
    s_add_u32 m0, s14, 19456
    s_add_u32 s12, s12, 28672
    s_setprio 0
    buffer_load_dwordx4 v1, s[60:63], s12 offen lds
    s_setprio 3
    s_waitcnt vmcnt(6)
    s_waitcnt lgkmcnt(0)
    v_mfma_f32_32x32x16_bf16 v[8:23], v[88:91], v[96:99], v[8:23]
    ds_read_b64_tr_b16 v[104:105], v2 offset:12288
    ds_read_b64_tr_b16 v[106:107], v2 offset:12800
    s_waitcnt lgkmcnt(1)
    v_mfma_f32_32x32x16_bf16 v[24:39], v[88:91], v[100:103], v[24:39]
    ds_read_b64_tr_b16 v[108:109], v3 offset:12288
    s_waitcnt lgkmcnt(1)
    v_mfma_f32_32x32x16_bf16 v[40:55], v[92:95], v[96:99], v[40:55]
    ds_read_b64_tr_b16 v[110:111], v3 offset:12800
    s_add_u32 m0, s14, 0
    s_add_u32 s12, s12, 28672
    s_setprio 0
    buffer_load_dwordx4 v1, s[60:63], s12 offen lds
    s_setprio 3
    s_waitcnt lgkmcnt(1)
    v_mfma_f32_32x32x16_bf16 v[56:71], v[92:95], v[100:103], v[56:71]
    ds_read_b128 v[112:115], v4 offset:2112
    ds_read_b128 v[116:119], v7 offset:2112
    s_add_u32 m0, s14, 1024
    s_add_u32 s12, s12, 28672
    s_setprio 0
    buffer_load_dwordx4 v1, s[60:63], s12 offen lds
    s_setprio 3
    s_waitcnt vmcnt(6)
    s_waitcnt lgkmcnt(0)
    v_mfma_f32_32x32x16_bf16 v[8:23], v[104:107], v[112:115], v[8:23]
    ds_read_b64_tr_b16 v[72:73], v2 offset:14336
    ds_read_b64_tr_b16 v[74:75], v2 offset:14848
    s_waitcnt lgkmcnt(1)
    v_mfma_f32_32x32x16_bf16 v[24:39], v[104:107], v[116:119], v[24:39]
    ds_read_b64_tr_b16 v[76:77], v3 offset:14336
    s_waitcnt lgkmcnt(1)
    v_mfma_f32_32x32x16_bf16 v[40:55], v[108:111], v[112:115], v[40:55]
    ds_read_b64_tr_b16 v[78:79], v3 offset:14848
    s_add_u32 m0, s14, 2048
    s_add_u32 s12, s12, 28672
    s_setprio 0
    buffer_load_dwordx4 v1, s[60:63], s12 offen lds
    s_setprio 3
    s_waitcnt lgkmcnt(1)
    v_mfma_f32_32x32x16_bf16 v[56:71], v[108:111], v[116:119], v[56:71]
    ds_read_b128 v[80:83], v4 offset:3168
    ds_read_b128 v[84:87], v7 offset:3168
    s_add_u32 m0, s14, 3072
    s_add_u32 s12, s12, 28672
    s_setprio 0
    buffer_load_dwordx4 v1, s[60:63], s12 offen lds
    s_setprio 3
    s_waitcnt vmcnt(6)
    s_waitcnt lgkmcnt(0)
    v_mfma_f32_32x32x16_bf16 v[8:23], v[72:75], v[80:83], v[8:23]
    ds_read_b64_tr_b16 v[88:89], v2 offset:16384
    ds_read_b64_tr_b16 v[90:91], v2 offset:16896
    s_bfe_u32 s93, s88, 0x50000
    s_lshl_b32 s93, s93, 14
    s_add_u32 m0, s14, 4096
    s_add_u32 s93, s93, s68
    s_setprio 0
    buffer_load_dwordx4 v160, s[52:55], s93 offen lds
    s_setprio 3
    s_waitcnt lgkmcnt(1)
    v_mfma_f32_32x32x16_bf16 v[24:39], v[72:75], v[84:87], v[24:39]
    ds_read_b64_tr_b16 v[92:93], v3 offset:16384
    s_add_u32 m0, s14, 5120
    s_add_u32 s93, s93, 8192
    s_setprio 0
    buffer_load_dwordx4 v160, s[52:55], s93 offen lds
    s_setprio 3
    s_waitcnt lgkmcnt(1)
    v_mfma_f32_32x32x16_bf16 v[40:55], v[76:79], v[80:83], v[40:55]
    ds_read_b64_tr_b16 v[94:95], v3 offset:16896
    s_bfe_u32 s93, s88, 0x50005
    s_lshl_b32 s93, s93, 14
    s_add_u32 m0, s14, 6144
    s_add_u32 s93, s93, s68
    s_setprio 0
    buffer_load_dwordx4 v160, s[52:55], s93 offen lds
    s_setprio 3
    s_waitcnt lgkmcnt(1)
    v_mfma_f32_32x32x16_bf16 v[56:71], v[76:79], v[84:87], v[56:71]
    ds_read_b128 v[96:99], v4 offset:4224
    ds_read_b128 v[100:103], v7 offset:4224
    s_add_u32 m0, s14, 7168
    s_add_u32 s93, s93, 8192
    s_setprio 0
    buffer_load_dwordx4 v160, s[52:55], s93 offen lds
    s_setprio 3
    s_waitcnt vmcnt(8)
    s_waitcnt lgkmcnt(0)
    v_mfma_f32_32x32x16_bf16 v[8:23], v[88:91], v[96:99], v[8:23]
    ds_read_b64_tr_b16 v[104:105], v2 offset:18432
    ds_read_b64_tr_b16 v[106:107], v2 offset:18944
    s_bfe_u32 s93, s88, 0x5000a
    s_lshl_b32 s93, s93, 14
    s_add_u32 m0, s14, 8192
    s_add_u32 s93, s93, s68
    s_setprio 0
    buffer_load_dwordx4 v160, s[52:55], s93 offen lds
    s_setprio 3
    s_waitcnt lgkmcnt(1)
    v_mfma_f32_32x32x16_bf16 v[24:39], v[88:91], v[100:103], v[24:39]
    ds_read_b64_tr_b16 v[108:109], v3 offset:18432
    s_add_u32 m0, s14, 9216
    s_add_u32 s93, s93, 8192
    s_setprio 0
    buffer_load_dwordx4 v160, s[52:55], s93 offen lds
    s_setprio 3
    s_waitcnt lgkmcnt(1)
    v_mfma_f32_32x32x16_bf16 v[40:55], v[92:95], v[96:99], v[40:55]
    ds_read_b64_tr_b16 v[110:111], v3 offset:18944
    s_bfe_u32 s93, s88, 0x5000f
    s_lshl_b32 s93, s93, 14
    s_add_u32 m0, s14, 10240
    s_add_u32 s93, s93, s68
    s_setprio 0
    buffer_load_dwordx4 v160, s[52:55], s93 offen lds
    s_setprio 3
    s_waitcnt lgkmcnt(1)
    v_mfma_f32_32x32x16_bf16 v[56:71], v[92:95], v[100:103], v[56:71]
    ds_read_b128 v[112:115], v4 offset:5280
    ds_read_b128 v[116:119], v7 offset:5280
    s_add_u32 m0, s14, 11264
    s_add_u32 s93, s93, 8192
    s_setprio 0
    buffer_load_dwordx4 v160, s[52:55], s93 offen lds
    s_setprio 3
    s_waitcnt vmcnt(10)
    s_waitcnt lgkmcnt(0)
    v_mfma_f32_32x32x16_bf16 v[8:23], v[104:107], v[112:115], v[8:23]
    ds_read_b64_tr_b16 v[72:73], v2 offset:0
    ds_read_b64_tr_b16 v[74:75], v2 offset:512
    s_bfe_u32 s93, s88, 0x50014
    s_lshl_b32 s93, s93, 14
    s_add_u32 m0, s14, 12288
    s_add_u32 s93, s93, s68
    s_setprio 0
    buffer_load_dwordx4 v160, s[52:55], s93 offen lds
    s_setprio 3
    s_waitcnt lgkmcnt(1)
    v_mfma_f32_32x32x16_bf16 v[24:39], v[104:107], v[116:119], v[24:39]
    ds_read_b64_tr_b16 v[76:77], v3 offset:0
    s_add_u32 m0, s14, 13312
    s_add_u32 s93, s93, 8192
    s_setprio 0
    buffer_load_dwordx4 v160, s[52:55], s93 offen lds
    s_setprio 3
    s_waitcnt lgkmcnt(1)
    v_mfma_f32_32x32x16_bf16 v[40:55], v[108:111], v[112:115], v[40:55]
    ds_read_b64_tr_b16 v[78:79], v3 offset:512
    s_bfe_u32 s93, s88, 0x50019
    s_lshl_b32 s93, s93, 14
    s_add_u32 m0, s14, 14336
    s_add_u32 s93, s93, s68
    s_setprio 0
    buffer_load_dwordx4 v160, s[52:55], s93 offen lds
    s_setprio 3
    s_waitcnt lgkmcnt(1)
    v_mfma_f32_32x32x16_bf16 v[56:71], v[108:111], v[116:119], v[56:71]
    ds_read_b128 v[80:83], v4 offset:6336
    ds_read_b128 v[84:87], v7 offset:6336
    s_add_u32 m0, s14, 15360
    s_add_u32 s93, s93, 8192
    s_setprio 0
    buffer_load_dwordx4 v160, s[52:55], s93 offen lds
    s_setprio 3
    s_waitcnt vmcnt(12)
    s_waitcnt lgkmcnt(0)
    v_mfma_f32_32x32x16_bf16 v[8:23], v[72:75], v[80:83], v[8:23]
    ds_read_b64_tr_b16 v[88:89], v2 offset:2048
    ds_read_b64_tr_b16 v[90:91], v2 offset:2560
    s_bfe_u32 s93, s89, 0x50000
    s_lshl_b32 s93, s93, 14
    s_add_u32 m0, s14, 16384
    s_add_u32 s93, s93, s68
    s_setprio 0
    buffer_load_dwordx4 v160, s[52:55], s93 offen lds
    s_setprio 3
    s_waitcnt lgkmcnt(1)
    v_mfma_f32_32x32x16_bf16 v[24:39], v[72:75], v[84:87], v[24:39]
    ds_read_b64_tr_b16 v[92:93], v3 offset:2048
    s_add_u32 m0, s14, 17408
    s_add_u32 s93, s93, 8192
    s_setprio 0
    buffer_load_dwordx4 v160, s[52:55], s93 offen lds
    s_setprio 3
    s_waitcnt lgkmcnt(1)
    v_mfma_f32_32x32x16_bf16 v[40:55], v[76:79], v[80:83], v[40:55]
    ds_read_b64_tr_b16 v[94:95], v3 offset:2560
    s_bfe_u32 s93, s89, 0x50005
    s_lshl_b32 s93, s93, 14
    s_add_u32 m0, s14, 18432
    s_add_u32 s93, s93, s68
    s_setprio 0
    buffer_load_dwordx4 v160, s[52:55], s93 offen lds
    s_setprio 3
    s_waitcnt lgkmcnt(1)
    v_mfma_f32_32x32x16_bf16 v[56:71], v[76:79], v[84:87], v[56:71]
    ds_read_b128 v[96:99], v4 offset:7392
    ds_read_b128 v[100:103], v7 offset:7392
    s_add_u32 m0, s14, 19456
    s_add_u32 s93, s93, 8192
    s_setprio 0
    buffer_load_dwordx4 v160, s[52:55], s93 offen lds
    s_setprio 3
    s_waitcnt lgkmcnt(0)
    v_mfma_f32_32x32x16_bf16 v[8:23], v[88:91], v[96:99], v[8:23]
    s_bfe_u32 s93, s89, 0x5000a
    s_lshl_b32 s93, s93, 14
    s_add_u32 m0, s14, 0
    s_add_u32 s93, s93, s68
    s_setprio 0
    buffer_load_dwordx4 v160, s[52:55], s93 offen lds
    s_setprio 3
    v_mfma_f32_32x32x16_bf16 v[24:39], v[88:91], v[100:103], v[24:39]
    s_add_u32 m0, s14, 1024
    s_add_u32 s93, s93, 8192
    s_setprio 0
    buffer_load_dwordx4 v160, s[52:55], s93 offen lds
    s_setprio 3
    v_mfma_f32_32x32x16_bf16 v[40:55], v[92:95], v[96:99], v[40:55]
    s_bfe_u32 s93, s89, 0x5000f
    s_lshl_b32 s93, s93, 14
    s_add_u32 m0, s14, 2048
    s_add_u32 s93, s93, s68
    s_setprio 0
    buffer_load_dwordx4 v160, s[52:55], s93 offen lds
    s_setprio 3
    v_mfma_f32_32x32x16_bf16 v[56:71], v[92:95], v[100:103], v[56:71]
    s_add_u32 m0, s14, 3072
    s_add_u32 s93, s93, 8192
    s_setprio 0
    buffer_load_dwordx4 v160, s[52:55], s93 offen lds
    s_setprio 3
    s_setprio 3
    s_mov_b64 exec, 1
    ds_add_u32 v164, v165 offset:24
    s_mov_b64 exec, -1
    v_mov_b32 v158, s43
    v_bfe_u32 v7, v0, 4, 1
    v_mul_u32_u24 v7, 114688, v7
    v_and_b32 v4, 15, v0
    v_lshl_add_u32 v7, v4, 7, v7
    s_mov_b32 s64, 0xbdd2d3e8
    s_mov_b32 s65, 0xbdd2d3e8
    s_mov_b32 s66, 1.0
    s_mov_b32 s67, 1.0
    v_mov_b32 v156, 0xc0135761
    v_mov_b32 v157, 0xc0135761
    s_lshl_b32 s6, s5, 1
    s_mul_i32 s6, s6, 112
    s_lshr_b32 s7, s13, 5
    s_add_u32 s6, s6, s7
    s_lshl_b32 s6, s6, 10
    s_add_u32 s6, s6, 5242880
    s_add_u32 s7, s6, 114688
    v_lshlrev_b32 v136, 16, v120
    v_and_b32 v137, 0xffff0000, v120
    v_lshlrev_b32 v138, 16, v121
    v_and_b32 v139, 0xffff0000, v121
    v_lshlrev_b32 v140, 16, v122
    v_and_b32 v141, 0xffff0000, v122
    v_lshlrev_b32 v142, 16, v123
    v_and_b32 v143, 0xffff0000, v123
    v_lshlrev_b32 v144, 16, v124
    v_and_b32 v145, 0xffff0000, v124
    v_lshlrev_b32 v146, 16, v125
    v_and_b32 v147, 0xffff0000, v125
    v_lshlrev_b32 v148, 16, v126
    v_and_b32 v149, 0xffff0000, v126
    v_lshlrev_b32 v150, 16, v127
    v_and_b32 v151, 0xffff0000, v127
    v_pk_fma_f32 v[8:9], v[8:9], v[152:153], v[136:137] op_sel_hi:[1,0,1]
    v_pk_fma_f32 v[10:11], v[10:11], v[152:153], v[138:139] op_sel_hi:[1,0,1]
    v_pk_fma_f32 v[12:13], v[12:13], v[152:153], v[140:141] op_sel_hi:[1,0,1]
    v_pk_fma_f32 v[14:15], v[14:15], v[152:153], v[142:143] op_sel_hi:[1,0,1]
    v_pk_mul_f32 v[72:73], v[8:9], v[8:9]
    v_pk_mul_f32 v[74:75], v[10:11], v[10:11]
    v_pk_mul_f32 v[76:77], v[12:13], v[12:13]
    v_pk_mul_f32 v[78:79], v[14:15], v[14:15]
    v_pk_fma_f32 v[72:73], v[72:73], s[64:65], v[156:157]
    v_pk_fma_f32 v[74:75], v[74:75], s[64:65], v[156:157]
    v_pk_fma_f32 v[76:77], v[76:77], s[64:65], v[156:157]
    v_pk_fma_f32 v[78:79], v[78:79], s[64:65], v[156:157]
    v_pk_mul_f32 v[72:73], v[72:73], v[8:9]
    v_pk_mul_f32 v[74:75], v[74:75], v[10:11]
    v_pk_mul_f32 v[76:77], v[76:77], v[12:13]
    v_pk_mul_f32 v[78:79], v[78:79], v[14:15]
    v_exp_f32 v72, v72
    v_exp_f32 v74, v74
    v_exp_f32 v76, v76
    v_exp_f32 v78, v78
    v_exp_f32 v73, v73
    v_exp_f32 v75, v75
    v_exp_f32 v77, v77
    v_exp_f32 v79, v79
    v_pk_add_f32 v[72:73], v[72:73], s[66:67]
    v_pk_add_f32 v[74:75], v[74:75], s[66:67]
    v_pk_add_f32 v[76:77], v[76:77], s[66:67]
    v_pk_add_f32 v[78:79], v[78:79], s[66:67]
    v_rcp_f32 v72, v72
    v_rcp_f32 v74, v74
    v_rcp_f32 v76, v76
    v_rcp_f32 v78, v78
    v_rcp_f32 v73, v73
    v_rcp_f32 v75, v75
    v_rcp_f32 v77, v77
    v_rcp_f32 v79, v79
    v_pk_mul_f32 v[72:73], v[72:73], v[8:9]
    v_pk_mul_f32 v[74:75], v[74:75], v[10:11]
    v_pk_mul_f32 v[76:77], v[76:77], v[12:13]
    v_pk_mul_f32 v[78:79], v[78:79], v[14:15]
    v_cvt_pk_bf16_f32 v80, v72, v73
    v_cvt_pk_bf16_f32 v81, v74, v75
    v_cvt_pk_bf16_f32 v82, v76, v77
    v_cvt_pk_bf16_f32 v83, v78, v79
    s_cmp_lg_u32 s70, 0
    s_cbranch_scc0 L_thr_55
    buffer_store_dwordx4 v[80:83], v161, s[48:51], s6 offen offset:0
    s_branch L_std_56
L_thr_55:
    buffer_store_dwordx4 v[80:83], v161, s[48:51], s6 offen offset:0 sc1
L_std_56:
    s_mov_b32 s94, s6
    s_mov_b32 s95, s7
L_spin_57:
    ds_read_b32 v4, v164 offset:24
    s_waitcnt lgkmcnt(0)
    v_readfirstlane_b32 s6, v4
    s_nop 0
    s_bfe_u32 s7, s6, 0x80000
    s_cmp_ge_u32 s7, 4
    s_cbranch_scc1 L_spun_58
    s_sleep 1
    s_sub_u32 s86, s86, 1
    s_cbranch_scc0 L_spin_57
    s_mov_b32 s86, 0
L_spun_58:
    s_mov_b32 s6, s94
    s_mov_b32 s7, s95
    s_lshl_b32 s78, s10, 14
    s_sub_u32 s8, s14, s78
    v_subrev_u32 v5, s8, v162
    v_subrev_u32 v7, s8, v163
    s_bfe_u32 s93, s89, 0x50014
    s_lshl_b32 s93, s93, 14
    s_add_u32 m0, s78, 0
    s_add_u32 s93, s93, s68
    s_setprio 0
    buffer_load_dwordx4 v160, s[52:55], s93 offen lds
    s_setprio 3
    s_add_u32 m0, s78, 1024
    s_add_u32 s93, s93, 8192
    s_setprio 0
    buffer_load_dwordx4 v160, s[52:55], s93 offen lds
    s_setprio 3
    s_bfe_u32 s93, s89, 0x50019
    s_lshl_b32 s93, s93, 14
    s_add_u32 m0, s78, 2048
    s_add_u32 s93, s93, s68
    s_setprio 0
    buffer_load_dwordx4 v160, s[52:55], s93 offen lds
    s_setprio 3
    s_add_u32 m0, s78, 3072
    s_add_u32 s93, s93, 8192
    s_setprio 0
    buffer_load_dwordx4 v160, s[52:55], s93 offen lds
    s_setprio 3
    v_pk_fma_f32 v[16:17], v[16:17], v[152:153], v[144:145] op_sel_hi:[1,0,1]
    v_pk_fma_f32 v[18:19], v[18:19], v[152:153], v[146:147] op_sel_hi:[1,0,1]
    v_pk_fma_f32 v[20:21], v[20:21], v[152:153], v[148:149] op_sel_hi:[1,0,1]
    v_pk_fma_f32 v[22:23], v[22:23], v[152:153], v[150:151] op_sel_hi:[1,0,1]
    v_pk_mul_f32 v[72:73], v[16:17], v[16:17]
    v_pk_mul_f32 v[74:75], v[18:19], v[18:19]
    v_pk_mul_f32 v[76:77], v[20:21], v[20:21]
    v_pk_mul_f32 v[78:79], v[22:23], v[22:23]
    v_pk_fma_f32 v[72:73], v[72:73], s[64:65], v[156:157]
    v_pk_fma_f32 v[74:75], v[74:75], s[64:65], v[156:157]
    v_pk_fma_f32 v[76:77], v[76:77], s[64:65], v[156:157]
    v_pk_fma_f32 v[78:79], v[78:79], s[64:65], v[156:157]
    v_pk_mul_f32 v[72:73], v[72:73], v[16:17]
    v_pk_mul_f32 v[74:75], v[74:75], v[18:19]
    v_pk_mul_f32 v[76:77], v[76:77], v[20:21]
    v_pk_mul_f32 v[78:79], v[78:79], v[22:23]
    v_exp_f32 v72, v72
    v_exp_f32 v74, v74
    v_exp_f32 v76, v76
    v_exp_f32 v78, v78
    v_exp_f32 v73, v73
    v_exp_f32 v75, v75
    v_exp_f32 v77, v77
    v_exp_f32 v79, v79
    v_pk_add_f32 v[72:73], v[72:73], s[66:67]
    v_pk_add_f32 v[74:75], v[74:75], s[66:67]
    v_pk_add_f32 v[76:77], v[76:77], s[66:67]
    v_pk_add_f32 v[78:79], v[78:79], s[66:67]
    v_rcp_f32 v72, v72
    v_rcp_f32 v74, v74
    v_rcp_f32 v76, v76
    v_rcp_f32 v78, v78
    v_rcp_f32 v73, v73
    v_rcp_f32 v75, v75
    v_rcp_f32 v77, v77
    v_rcp_f32 v79, v79
    v_pk_mul_f32 v[72:73], v[72:73], v[16:17]
    v_pk_mul_f32 v[74:75], v[74:75], v[18:19]
    v_pk_mul_f32 v[76:77], v[76:77], v[20:21]
    v_pk_mul_f32 v[78:79], v[78:79], v[22:23]
    v_cvt_pk_bf16_f32 v84, v72, v73
    v_cvt_pk_bf16_f32 v85, v74, v75
    v_cvt_pk_bf16_f32 v86, v76, v77
    v_cvt_pk_bf16_f32 v87, v78, v79
    s_cmp_lg_u32 s70, 0
    s_cbranch_scc0 L_thr_59
    buffer_store_dwordx4 v[84:87], v161, s[48:51], s6 offen offset:1024
    s_branch L_std_60
L_thr_59:
    buffer_store_dwordx4 v[84:87], v161, s[48:51], s6 offen offset:1024 sc1
L_std_60:
    s_bfe_u32 s93, s90, 0x50000
    s_lshl_b32 s93, s93, 14
    s_add_u32 m0, s78, 4096
    s_add_u32 s93, s93, s68
    s_setprio 0
    buffer_load_dwordx4 v160, s[52:55], s93 offen lds
    s_setprio 3
    s_add_u32 m0, s78, 5120
    s_add_u32 s93, s93, 8192
    s_setprio 0
    buffer_load_dwordx4 v160, s[52:55], s93 offen lds
    s_setprio 3
    s_bfe_u32 s93, s90, 0x50005
    s_lshl_b32 s93, s93, 14
    s_add_u32 m0, s78, 6144
    s_add_u32 s93, s93, s68
    s_setprio 0
    buffer_load_dwordx4 v160, s[52:55], s93 offen lds
    s_setprio 3
    s_add_u32 m0, s78, 7168
    s_add_u32 s93, s93, 8192
    s_setprio 0
    buffer_load_dwordx4 v160, s[52:55], s93 offen lds
    s_setprio 3
    v_pk_fma_f32 v[24:25], v[24:25], v[154:155], v[136:137] op_sel_hi:[1,0,1]
    v_pk_fma_f32 v[26:27], v[26:27], v[154:155], v[138:139] op_sel_hi:[1,0,1]
    v_pk_fma_f32 v[28:29], v[28:29], v[154:155], v[140:141] op_sel_hi:[1,0,1]
    v_pk_fma_f32 v[30:31], v[30:31], v[154:155], v[142:143] op_sel_hi:[1,0,1]
    v_pk_mul_f32 v[72:73], v[24:25], v[24:25]
    v_pk_mul_f32 v[74:75], v[26:27], v[26:27]
    v_pk_mul_f32 v[76:77], v[28:29], v[28:29]
    v_pk_mul_f32 v[78:79], v[30:31], v[30:31]
    v_pk_fma_f32 v[72:73], v[72:73], s[64:65], v[156:157]
    v_pk_fma_f32 v[74:75], v[74:75], s[64:65], v[156:157]
    v_pk_fma_f32 v[76:77], v[76:77], s[64:65], v[156:157]
    v_pk_fma_f32 v[78:79], v[78:79], s[64:65], v[156:157]
    v_pk_mul_f32 v[72:73], v[72:73], v[24:25]
    v_pk_mul_f32 v[74:75], v[74:75], v[26:27]
    v_pk_mul_f32 v[76:77], v[76:77], v[28:29]
    v_pk_mul_f32 v[78:79], v[78:79], v[30:31]
    v_exp_f32 v72, v72
    v_exp_f32 v74, v74
    v_exp_f32 v76, v76
    v_exp_f32 v78, v78
    v_exp_f32 v73, v73
    v_exp_f32 v75, v75
    v_exp_f32 v77, v77
    v_exp_f32 v79, v79
    v_pk_add_f32 v[72:73], v[72:73], s[66:67]
    v_pk_add_f32 v[74:75], v[74:75], s[66:67]
    v_pk_add_f32 v[76:77], v[76:77], s[66:67]
    v_pk_add_f32 v[78:79], v[78:79], s[66:67]
    v_rcp_f32 v72, v72
    v_rcp_f32 v74, v74
    v_rcp_f32 v76, v76
    v_rcp_f32 v78, v78
    v_rcp_f32 v73, v73
    v_rcp_f32 v75, v75
    v_rcp_f32 v77, v77
    v_rcp_f32 v79, v79
    v_pk_mul_f32 v[72:73], v[72:73], v[24:25]
    v_pk_mul_f32 v[74:75], v[74:75], v[26:27]
    v_pk_mul_f32 v[76:77], v[76:77], v[28:29]
    v_pk_mul_f32 v[78:79], v[78:79], v[30:31]
    v_cvt_pk_bf16_f32 v80, v72, v73
    v_cvt_pk_bf16_f32 v81, v74, v75
    v_cvt_pk_bf16_f32 v82, v76, v77
    v_cvt_pk_bf16_f32 v83, v78, v79
    s_cmp_lg_u32 s70, 0
    s_cbranch_scc0 L_thr_61
    buffer_store_dwordx4 v[80:83], v161, s[48:51], s7 offen offset:0
    s_branch L_std_62
L_thr_61:
    buffer_store_dwordx4 v[80:83], v161, s[48:51], s7 offen offset:0 sc1
L_std_62:
    s_bfe_u32 s93, s90, 0x5000a
    s_lshl_b32 s93, s93, 14
    s_add_u32 m0, s78, 8192
    s_add_u32 s93, s93, s68
    s_setprio 0
    buffer_load_dwordx4 v160, s[52:55], s93 offen lds
    s_setprio 3
    s_add_u32 m0, s78, 9216
    s_add_u32 s93, s93, 8192
    s_setprio 0
    buffer_load_dwordx4 v160, s[52:55], s93 offen lds
    s_setprio 3
    s_bfe_u32 s93, s90, 0x5000f
    s_lshl_b32 s93, s93, 14
    s_add_u32 m0, s78, 10240
    s_add_u32 s93, s93, s68
    s_setprio 0
    buffer_load_dwordx4 v160, s[52:55], s93 offen lds
    s_setprio 3
    s_add_u32 m0, s78, 11264
    s_add_u32 s93, s93, 8192
    s_setprio 0
    buffer_load_dwordx4 v160, s[52:55], s93 offen lds
    s_setprio 3
    v_pk_fma_f32 v[32:33], v[32:33], v[154:155], v[144:145] op_sel_hi:[1,0,1]
    v_pk_fma_f32 v[34:35], v[34:35], v[154:155], v[146:147] op_sel_hi:[1,0,1]
    v_pk_fma_f32 v[36:37], v[36:37], v[154:155], v[148:149] op_sel_hi:[1,0,1]
    v_pk_fma_f32 v[38:39], v[38:39], v[154:155], v[150:151] op_sel_hi:[1,0,1]
    v_pk_mul_f32 v[72:73], v[32:33], v[32:33]
    v_pk_mul_f32 v[74:75], v[34:35], v[34:35]
    v_pk_mul_f32 v[76:77], v[36:37], v[36:37]
    v_pk_mul_f32 v[78:79], v[38:39], v[38:39]
    v_pk_fma_f32 v[72:73], v[72:73], s[64:65], v[156:157]
    v_pk_fma_f32 v[74:75], v[74:75], s[64:65], v[156:157]
    v_pk_fma_f32 v[76:77], v[76:77], s[64:65], v[156:157]
    v_pk_fma_f32 v[78:79], v[78:79], s[64:65], v[156:157]
    v_pk_mul_f32 v[72:73], v[72:73], v[32:33]
    v_pk_mul_f32 v[74:75], v[74:75], v[34:35]
    v_pk_mul_f32 v[76:77], v[76:77], v[36:37]
    v_pk_mul_f32 v[78:79], v[78:79], v[38:39]
    v_exp_f32 v72, v72
    v_exp_f32 v74, v74
    v_exp_f32 v76, v76
    v_exp_f32 v78, v78
    v_exp_f32 v73, v73
    v_exp_f32 v75, v75
    v_exp_f32 v77, v77
    v_exp_f32 v79, v79
    v_pk_add_f32 v[72:73], v[72:73], s[66:67]
    v_pk_add_f32 v[74:75], v[74:75], s[66:67]
    v_pk_add_f32 v[76:77], v[76:77], s[66:67]
    v_pk_add_f32 v[78:79], v[78:79], s[66:67]
    v_rcp_f32 v72, v72
    v_rcp_f32 v74, v74
    v_rcp_f32 v76, v76
    v_rcp_f32 v78, v78
    v_rcp_f32 v73, v73
    v_rcp_f32 v75, v75
    v_rcp_f32 v77, v77
    v_rcp_f32 v79, v79
    v_pk_mul_f32 v[72:73], v[72:73], v[32:33]
    v_pk_mul_f32 v[74:75], v[74:75], v[34:35]
    v_pk_mul_f32 v[76:77], v[76:77], v[36:37]
    v_pk_mul_f32 v[78:79], v[78:79], v[38:39]
    v_cvt_pk_bf16_f32 v84, v72, v73
    v_cvt_pk_bf16_f32 v85, v74, v75
    v_cvt_pk_bf16_f32 v86, v76, v77
    v_cvt_pk_bf16_f32 v87, v78, v79
    s_cmp_lg_u32 s70, 0
    s_cbranch_scc0 L_thr_63
    buffer_store_dwordx4 v[84:87], v161, s[48:51], s7 offen offset:1024
    s_branch L_std_64
L_thr_63:
    buffer_store_dwordx4 v[84:87], v161, s[48:51], s7 offen offset:1024 sc1
L_std_64:
    s_bfe_u32 s93, s90, 0x50014
    s_lshl_b32 s93, s93, 14
    s_add_u32 m0, s78, 12288
    s_add_u32 s93, s93, s68
    s_setprio 0
    buffer_load_dwordx4 v160, s[52:55], s93 offen lds
    s_setprio 3
    s_add_u32 m0, s78, 13312
    s_add_u32 s93, s93, 8192
    s_setprio 0
    buffer_load_dwordx4 v160, s[52:55], s93 offen lds
    s_setprio 3
    s_bfe_u32 s93, s90, 0x50019
    s_lshl_b32 s93, s93, 14
    s_add_u32 m0, s78, 14336
    s_add_u32 s93, s93, s68
    s_setprio 0
    buffer_load_dwordx4 v160, s[52:55], s93 offen lds
    s_setprio 3
    s_add_u32 m0, s78, 15360
    s_add_u32 s93, s93, 8192
    s_setprio 0
    buffer_load_dwordx4 v160, s[52:55], s93 offen lds
    s_setprio 3
    v_lshlrev_b32 v136, 16, v128
    v_and_b32 v137, 0xffff0000, v128
    v_lshlrev_b32 v138, 16, v129
    v_and_b32 v139, 0xffff0000, v129
    v_lshlrev_b32 v140, 16, v130
    v_and_b32 v141, 0xffff0000, v130
    v_lshlrev_b32 v142, 16, v131
    v_and_b32 v143, 0xffff0000, v131
    v_lshlrev_b32 v144, 16, v132
    v_and_b32 v145, 0xffff0000, v132
    v_lshlrev_b32 v146, 16, v133
    v_and_b32 v147, 0xffff0000, v133
    v_lshlrev_b32 v148, 16, v134
    v_and_b32 v149, 0xffff0000, v134
    v_lshlrev_b32 v150, 16, v135
    v_and_b32 v151, 0xffff0000, v135
    v_pk_fma_f32 v[40:41], v[40:41], v[152:153], v[136:137] op_sel_hi:[1,0,1]
    v_pk_fma_f32 v[42:43], v[42:43], v[152:153], v[138:139] op_sel_hi:[1,0,1]
    v_pk_fma_f32 v[44:45], v[44:45], v[152:153], v[140:141] op_sel_hi:[1,0,1]
    v_pk_fma_f32 v[46:47], v[46:47], v[152:153], v[142:143] op_sel_hi:[1,0,1]
    v_pk_mul_f32 v[72:73], v[40:41], v[40:41]
    v_pk_mul_f32 v[74:75], v[42:43], v[42:43]
    v_pk_mul_f32 v[76:77], v[44:45], v[44:45]
    v_pk_mul_f32 v[78:79], v[46:47], v[46:47]
    v_pk_fma_f32 v[72:73], v[72:73], s[64:65], v[156:157]
    v_pk_fma_f32 v[74:75], v[74:75], s[64:65], v[156:157]
    v_pk_fma_f32 v[76:77], v[76:77], s[64:65], v[156:157]
    v_pk_fma_f32 v[78:79], v[78:79], s[64:65], v[156:157]
    v_pk_mul_f32 v[72:73], v[72:73], v[40:41]
    v_pk_mul_f32 v[74:75], v[74:75], v[42:43]
    v_pk_mul_f32 v[76:77], v[76:77], v[44:45]
    v_pk_mul_f32 v[78:79], v[78:79], v[46:47]
    v_exp_f32 v72, v72
    v_exp_f32 v74, v74
    v_exp_f32 v76, v76
    v_exp_f32 v78, v78
    v_exp_f32 v73, v73
    v_exp_f32 v75, v75
    v_exp_f32 v77, v77
    v_exp_f32 v79, v79
    v_pk_add_f32 v[72:73], v[72:73], s[66:67]
    v_pk_add_f32 v[74:75], v[74:75], s[66:67]
    v_pk_add_f32 v[76:77], v[76:77], s[66:67]
    v_pk_add_f32 v[78:79], v[78:79], s[66:67]
    v_rcp_f32 v72, v72
    v_rcp_f32 v74, v74
    v_rcp_f32 v76, v76
    v_rcp_f32 v78, v78
    v_rcp_f32 v73, v73
    v_rcp_f32 v75, v75
    v_rcp_f32 v77, v77
    v_rcp_f32 v79, v79
    v_pk_mul_f32 v[72:73], v[72:73], v[40:41]
    v_pk_mul_f32 v[74:75], v[74:75], v[42:43]
    v_pk_mul_f32 v[76:77], v[76:77], v[44:45]
    v_pk_mul_f32 v[78:79], v[78:79], v[46:47]
    v_cvt_pk_bf16_f32 v80, v72, v73
    v_cvt_pk_bf16_f32 v81, v74, v75
    v_cvt_pk_bf16_f32 v82, v76, v77
    v_cvt_pk_bf16_f32 v83, v78, v79
    s_cmp_lg_u32 s70, 0
    s_cbranch_scc0 L_thr_65
    buffer_store_dwordx4 v[80:83], v161, s[48:51], s6 offen offset:2048
    s_branch L_std_66
L_thr_65:
    buffer_store_dwordx4 v[80:83], v161, s[48:51], s6 offen offset:2048 sc1
L_std_66:
    v_pk_fma_f32 v[48:49], v[48:49], v[152:153], v[144:145] op_sel_hi:[1,0,1]
    v_pk_fma_f32 v[50:51], v[50:51], v[152:153], v[146:147] op_sel_hi:[1,0,1]
    v_pk_fma_f32 v[52:53], v[52:53], v[152:153], v[148:149] op_sel_hi:[1,0,1]
    v_pk_fma_f32 v[54:55], v[54:55], v[152:153], v[150:151] op_sel_hi:[1,0,1]
    v_pk_mul_f32 v[72:73], v[48:49], v[48:49]
    v_pk_mul_f32 v[74:75], v[50:51], v[50:51]
    v_pk_mul_f32 v[76:77], v[52:53], v[52:53]
    v_pk_mul_f32 v[78:79], v[54:55], v[54:55]
    v_pk_fma_f32 v[72:73], v[72:73], s[64:65], v[156:157]
    v_pk_fma_f32 v[74:75], v[74:75], s[64:65], v[156:157]
    v_pk_fma_f32 v[76:77], v[76:77], s[64:65], v[156:157]
    v_pk_fma_f32 v[78:79], v[78:79], s[64:65], v[156:157]
    v_pk_mul_f32 v[72:73], v[72:73], v[48:49]
    v_pk_mul_f32 v[74:75], v[74:75], v[50:51]
    v_pk_mul_f32 v[76:77], v[76:77], v[52:53]
    v_pk_mul_f32 v[78:79], v[78:79], v[54:55]
    v_exp_f32 v72, v72
    v_exp_f32 v74, v74
    v_exp_f32 v76, v76
    v_exp_f32 v78, v78
    v_exp_f32 v73, v73
    v_exp_f32 v75, v75
    v_exp_f32 v77, v77
    v_exp_f32 v79, v79
    v_pk_add_f32 v[72:73], v[72:73], s[66:67]
    v_pk_add_f32 v[74:75], v[74:75], s[66:67]
    v_pk_add_f32 v[76:77], v[76:77], s[66:67]
    v_pk_add_f32 v[78:79], v[78:79], s[66:67]
    v_rcp_f32 v72, v72
    v_rcp_f32 v74, v74
    v_rcp_f32 v76, v76
    v_rcp_f32 v78, v78
    v_rcp_f32 v73, v73
    v_rcp_f32 v75, v75
    v_rcp_f32 v77, v77
    v_rcp_f32 v79, v79
    v_pk_mul_f32 v[72:73], v[72:73], v[48:49]
    v_pk_mul_f32 v[74:75], v[74:75], v[50:51]
    v_pk_mul_f32 v[76:77], v[76:77], v[52:53]
    v_pk_mul_f32 v[78:79], v[78:79], v[54:55]
    v_cvt_pk_bf16_f32 v84, v72, v73
    v_cvt_pk_bf16_f32 v85, v74, v75
    v_cvt_pk_bf16_f32 v86, v76, v77
    v_cvt_pk_bf16_f32 v87, v78, v79
    s_cmp_lg_u32 s70, 0
    s_cbranch_scc0 L_thr_67
    buffer_store_dwordx4 v[84:87], v161, s[48:51], s6 offen offset:3072
    s_branch L_std_68
L_thr_67:
    buffer_store_dwordx4 v[84:87], v161, s[48:51], s6 offen offset:3072 sc1
L_std_68:
    s_waitcnt vmcnt(6)
    s_mov_b64 exec, 1
    s_cmp_lg_u32 s70, 0
    s_cbranch_scc0 L_thr_69
    buffer_store_dword v158, off, s[48:51], s79 offset:0
    s_branch L_std_70
L_thr_69:
    buffer_store_dword v158, off, s[48:51], s79 offset:0 sc1
L_std_70:
    s_mov_b64 exec, -1
    v_mov_b32 v4, 0x10000
    s_mov_b64 exec, 1
    ds_add_u32 v164, v4 offset:24
    s_mov_b64 exec, -1
    v_pk_fma_f32 v[56:57], v[56:57], v[154:155], v[136:137] op_sel_hi:[1,0,1]
    v_pk_fma_f32 v[58:59], v[58:59], v[154:155], v[138:139] op_sel_hi:[1,0,1]
    v_pk_fma_f32 v[60:61], v[60:61], v[154:155], v[140:141] op_sel_hi:[1,0,1]
    v_pk_fma_f32 v[62:63], v[62:63], v[154:155], v[142:143] op_sel_hi:[1,0,1]
    v_pk_mul_f32 v[72:73], v[56:57], v[56:57]
    v_pk_mul_f32 v[74:75], v[58:59], v[58:59]
    v_pk_mul_f32 v[76:77], v[60:61], v[60:61]
    v_pk_mul_f32 v[78:79], v[62:63], v[62:63]
    v_pk_fma_f32 v[72:73], v[72:73], s[64:65], v[156:157]
    v_pk_fma_f32 v[74:75], v[74:75], s[64:65], v[156:157]
    v_pk_fma_f32 v[76:77], v[76:77], s[64:65], v[156:157]
    v_pk_fma_f32 v[78:79], v[78:79], s[64:65], v[156:157]
    v_pk_mul_f32 v[72:73], v[72:73], v[56:57]
    v_pk_mul_f32 v[74:75], v[74:75], v[58:59]
    v_pk_mul_f32 v[76:77], v[76:77], v[60:61]
    v_pk_mul_f32 v[78:79], v[78:79], v[62:63]
    v_exp_f32 v72, v72
    v_exp_f32 v74, v74
    v_exp_f32 v76, v76
    v_exp_f32 v78, v78
    v_exp_f32 v73, v73
    v_exp_f32 v75, v75
    v_exp_f32 v77, v77
    v_exp_f32 v79, v79
    v_pk_add_f32 v[72:73], v[72:73], s[66:67]
    v_pk_add_f32 v[74:75], v[74:75], s[66:67]
    v_pk_add_f32 v[76:77], v[76:77], s[66:67]
    v_pk_add_f32 v[78:79], v[78:79], s[66:67]
    v_rcp_f32 v72, v72
    v_rcp_f32 v74, v74
    v_rcp_f32 v76, v76
    v_rcp_f32 v78, v78
    v_rcp_f32 v73, v73
    v_rcp_f32 v75, v75
    v_rcp_f32 v77, v77
    v_rcp_f32 v79, v79
    v_pk_mul_f32 v[72:73], v[72:73], v[56:57]
    v_pk_mul_f32 v[74:75], v[74:75], v[58:59]
    v_pk_mul_f32 v[76:77], v[76:77], v[60:61]
    v_pk_mul_f32 v[78:79], v[78:79], v[62:63]
    v_cvt_pk_bf16_f32 v80, v72, v73
    v_cvt_pk_bf16_f32 v81, v74, v75
    v_cvt_pk_bf16_f32 v82, v76, v77
    v_cvt_pk_bf16_f32 v83, v78, v79
    s_cmp_lg_u32 s70, 0
    s_cbranch_scc0 L_thr_71
    buffer_store_dwordx4 v[80:83], v161, s[48:51], s7 offen offset:2048
    s_branch L_std_72
L_thr_71:
    buffer_store_dwordx4 v[80:83], v161, s[48:51], s7 offen offset:2048 sc1
L_std_72:
    v_pk_fma_f32 v[64:65], v[64:65], v[154:155], v[144:145] op_sel_hi:[1,0,1]
    v_pk_fma_f32 v[66:67], v[66:67], v[154:155], v[146:147] op_sel_hi:[1,0,1]
    v_pk_fma_f32 v[68:69], v[68:69], v[154:155], v[148:149] op_sel_hi:[1,0,1]
    v_pk_fma_f32 v[70:71], v[70:71], v[154:155], v[150:151] op_sel_hi:[1,0,1]
    v_pk_mul_f32 v[72:73], v[64:65], v[64:65]
    v_pk_mul_f32 v[74:75], v[66:67], v[66:67]
    v_pk_mul_f32 v[76:77], v[68:69], v[68:69]
    v_pk_mul_f32 v[78:79], v[70:71], v[70:71]
    v_pk_fma_f32 v[72:73], v[72:73], s[64:65], v[156:157]
    v_pk_fma_f32 v[74:75], v[74:75], s[64:65], v[156:157]
    v_pk_fma_f32 v[76:77], v[76:77], s[64:65], v[156:157]
    v_pk_fma_f32 v[78:79], v[78:79], s[64:65], v[156:157]
    v_pk_mul_f32 v[72:73], v[72:73], v[64:65]
    v_pk_mul_f32 v[74:75], v[74:75], v[66:67]
    v_pk_mul_f32 v[76:77], v[76:77], v[68:69]
    v_pk_mul_f32 v[78:79], v[78:79], v[70:71]
    v_exp_f32 v72, v72
    v_exp_f32 v74, v74
    v_exp_f32 v76, v76
    v_exp_f32 v78, v78
    v_exp_f32 v73, v73
    v_exp_f32 v75, v75
    v_exp_f32 v77, v77
    v_exp_f32 v79, v79
    v_pk_add_f32 v[72:73], v[72:73], s[66:67]
    v_pk_add_f32 v[74:75], v[74:75], s[66:67]
    v_pk_add_f32 v[76:77], v[76:77], s[66:67]
    v_pk_add_f32 v[78:79], v[78:79], s[66:67]
    v_rcp_f32 v72, v72
    v_rcp_f32 v74, v74
    v_rcp_f32 v76, v76
    v_rcp_f32 v78, v78
    v_rcp_f32 v73, v73
    v_rcp_f32 v75, v75
    v_rcp_f32 v77, v77
    v_rcp_f32 v79, v79
    v_pk_mul_f32 v[72:73], v[72:73], v[64:65]
    v_pk_mul_f32 v[74:75], v[74:75], v[66:67]
    v_pk_mul_f32 v[76:77], v[76:77], v[68:69]
    v_pk_mul_f32 v[78:79], v[78:79], v[70:71]
    v_cvt_pk_bf16_f32 v84, v72, v73
    v_cvt_pk_bf16_f32 v85, v74, v75
    v_cvt_pk_bf16_f32 v86, v76, v77
    v_cvt_pk_bf16_f32 v87, v78, v79
    s_cmp_lg_u32 s70, 0
    s_cbranch_scc0 L_thr_73
    buffer_store_dwordx4 v[84:87], v161, s[48:51], s7 offen offset:3072
    s_branch L_std_74
L_thr_73:
    buffer_store_dwordx4 v[84:87], v161, s[48:51], s7 offen offset:3072 sc1
L_std_74:
    buffer_load_dword v1, v159, s[48:51], s80 offen sc1
    s_waitcnt vmcnt(0)
    s_mov_b64 exec, 1
    s_cmp_lg_u32 s70, 0
    s_cbranch_scc0 L_thr_75
    buffer_store_dword v158, off, s[48:51], s79 offset:16
    s_branch L_std_76
L_thr_75:
    buffer_store_dword v158, off, s[48:51], s79 offset:16 sc1
L_std_76:
    s_mov_b64 exec, -1
    v_mov_b32 v4, 0x100
    s_mov_b64 exec, 1
    ds_add_u32 v164, v4 offset:24
    s_mov_b64 exec, -1
    s_branch L_f1e_48
L_f1w3_47:
    s_add_u32 m0, s14, 0
    s_nop 0
    s_setprio 0
    buffer_load_dwordx4 v1, s[60:63], s12 offen lds
    s_setprio 3
    s_add_u32 m0, s14, 1024
    s_add_u32 s12, s12, 28672
    s_setprio 0
    buffer_load_dwordx4 v1, s[60:63], s12 offen lds
    s_setprio 3
    s_add_u32 m0, s14, 2048
    s_add_u32 s12, s12, 28672
    s_setprio 0
    buffer_load_dwordx4 v1, s[60:63], s12 offen lds
    s_setprio 3
    s_add_u32 m0, s14, 3072
    s_add_u32 s12, s12, 28672
    s_setprio 0
    buffer_load_dwordx4 v1, s[60:63], s12 offen lds
    s_setprio 3
    s_add_u32 m0, s14, 4096
    s_add_u32 s12, s12, 28672
    s_setprio 0
    buffer_load_dwordx4 v1, s[60:63], s12 offen lds
    s_setprio 3
    s_add_u32 m0, s14, 5120
    s_add_u32 s12, s12, 28672
    s_setprio 0
    buffer_load_dwordx4 v1, s[60:63], s12 offen lds
    s_setprio 3
    ds_read_b32 v152, v5 offset:0
    ds_read_b32 v154, v5 offset:128
    s_add_u32 s6, s11, 0
    s_and_b32 s6, s6, 3
    s_mul_i32 s6, s6, 8448
    s_add_u32 s7, s6, 33792
    v_add_u32 v4, s6, v158
    v_add_u32 v7, s7, v158
    s_waitcnt vmcnt(4)
    ds_read_b64_tr_b16 v[72:73], v2 offset:0
    ds_read_b64_tr_b16 v[74:75], v2 offset:512
    ds_read_b128 v[80:83], v4 offset:0
    ds_read_b128 v[84:87], v7 offset:0
    s_waitcnt vmcnt(2)
    s_waitcnt lgkmcnt(0)
    v_mfma_f32_32x32x16_bf16 v[8:23], v[72:75], v[80:83], 0
    ds_read_b64_tr_b16 v[88:89], v2 offset:2048
    ds_read_b64_tr_b16 v[90:91], v2 offset:2560
    s_add_u32 m0, s14, 6144
    s_add_u32 s12, s12, 28672
    s_setprio 0
    buffer_load_dwordx4 v1, s[60:63], s12 offen lds
    s_setprio 3
    s_add_u32 m0, s14, 7168
    s_add_u32 s12, s12, 28672
    s_setprio 0
    buffer_load_dwordx4 v1, s[60:63], s12 offen lds
    s_setprio 3
    s_waitcnt lgkmcnt(1)
    v_mfma_f32_32x32x16_bf16 v[24:39], v[72:75], v[84:87], 0
    ds_read_b128 v[96:99], v4 offset:1056
    ds_read_b128 v[100:103], v7 offset:1056
    s_add_u32 m0, s14, 8192
    s_add_u32 s12, s12, 28672
    s_setprio 0
    buffer_load_dwordx4 v1, s[60:63], s12 offen lds
    s_setprio 3
    s_add_u32 m0, s14, 9216
    s_add_u32 s12, s12, 28672
    s_setprio 0
    buffer_load_dwordx4 v1, s[60:63], s12 offen lds
    s_setprio 3
    s_waitcnt vmcnt(4)
    s_waitcnt lgkmcnt(0)
    v_mfma_f32_32x32x16_bf16 v[8:23], v[88:91], v[96:99], v[8:23]
    ds_read_b64_tr_b16 v[104:105], v2 offset:4096
    ds_read_b64_tr_b16 v[106:107], v2 offset:4608
    s_add_u32 m0, s14, 10240
    s_add_u32 s12, s12, 28672
    s_setprio 0
    buffer_load_dwordx4 v1, s[60:63], s12 offen lds
    s_setprio 3
    s_add_u32 m0, s14, 11264
    s_add_u32 s12, s12, 28672
    s_setprio 0
    buffer_load_dwordx4 v1, s[60:63], s12 offen lds
    s_setprio 3
    s_waitcnt lgkmcnt(1)
    v_mfma_f32_32x32x16_bf16 v[24:39], v[88:91], v[100:103], v[24:39]
    ds_read_b128 v[112:115], v4 offset:2112
    ds_read_b128 v[116:119], v7 offset:2112
    s_add_u32 m0, s14, 12288
    s_add_u32 s12, s12, 28672
    s_setprio 0
    buffer_load_dwordx4 v1, s[60:63], s12 offen lds
    s_setprio 3
    s_waitcnt vmcnt(5)
    s_waitcnt lgkmcnt(0)
    v_mfma_f32_32x32x16_bf16 v[8:23], v[104:107], v[112:115], v[8:23]
    ds_read_b64_tr_b16 v[72:73], v2 offset:6144
    ds_read_b64_tr_b16 v[74:75], v2 offset:6656
    s_add_u32 m0, s14, 13312
    s_add_u32 s12, s12, 28672
    s_setprio 0
    buffer_load_dwordx4 v1, s[60:63], s12 offen lds
    s_setprio 3
    s_add_u32 m0, s14, 14336
    s_add_u32 s12, s12, 28672
    s_setprio 0
    buffer_load_dwordx4 v1, s[60:63], s12 offen lds
    s_setprio 3
    s_waitcnt lgkmcnt(1)
    v_mfma_f32_32x32x16_bf16 v[24:39], v[104:107], v[116:119], v[24:39]
    ds_read_b128 v[80:83], v4 offset:3168
    ds_read_b128 v[84:87], v7 offset:3168
    s_add_u32 m0, s14, 15360
    s_add_u32 s12, s12, 28672
    s_setprio 0
    buffer_load_dwordx4 v1, s[60:63], s12 offen lds
    s_setprio 3
    s_waitcnt vmcnt(6)
    s_waitcnt lgkmcnt(0)
    v_mfma_f32_32x32x16_bf16 v[8:23], v[72:75], v[80:83], v[8:23]
    ds_read_b64_tr_b16 v[88:89], v2 offset:8192
    ds_read_b64_tr_b16 v[90:91], v2 offset:8704
    s_cmp_eq_u32 s11, 3
    s_cselect_b32 s9, 1835008, 0
    s_sub_u32 s12, s12, s9
    s_add_u32 m0, s14, 16384
    s_add_u32 s12, s12, 28672
    s_setprio 0
    buffer_load_dwordx4 v1, s[60:63], s12 offen lds
    s_setprio 3
    s_waitcnt lgkmcnt(1)
    v_mfma_f32_32x32x16_bf16 v[24:39], v[72:75], v[84:87], v[24:39]
    ds_read_b128 v[96:99], v4 offset:4224
    ds_read_b128 v[100:103], v7 offset:4224
    s_add_u32 m0, s14, 17408
    s_add_u32 s12, s12, 28672
    s_setprio 0
    buffer_load_dwordx4 v1, s[60:63], s12 offen lds
    s_setprio 3
    s_waitcnt vmcnt(6)
    s_waitcnt lgkmcnt(0)
    v_mfma_f32_32x32x16_bf16 v[8:23], v[88:91], v[96:99], v[8:23]
    ds_read_b64_tr_b16 v[104:105], v2 offset:10240
    ds_read_b64_tr_b16 v[106:107], v2 offset:10752
    s_add_u32 m0, s14, 18432
    s_add_u32 s12, s12, 28672
    s_setprio 0
    buffer_load_dwordx4 v1, s[60:63], s12 offen lds
    s_setprio 3
    s_waitcnt lgkmcnt(1)
    v_mfma_f32_32x32x16_bf16 v[24:39], v[88:91], v[100:103], v[24:39]
    ds_read_b128 v[112:115], v4 offset:5280
    ds_read_b128 v[116:119], v7 offset:5280
    s_add_u32 m0, s14, 19456
    s_add_u32 s12, s12, 28672
    s_setprio 0
    buffer_load_dwordx4 v1, s[60:63], s12 offen lds
    s_setprio 3
    s_cmp_lg_u32 s10, 1
    s_cbranch_scc1 L_notouch_77
    v_min_u32 v136, 55, v0
    v_lshlrev_b32 v136, 7, v136
    s_mul_i32 s6, s42, 7168
    buffer_load_dword v6, v136, s[52:55], s6 offen
L_notouch_77:
    s_cmp_lg_u32 s10, 2
    s_cbranch_scc1 L_notouch_78
    v_min_u32 v136, 15, v0
    v_lshlrev_b32 v136, 7, v136
    s_mul_i32 s6, s42, 2048
    buffer_load_dword v6, v136, s[56:59], s6 offen
L_notouch_78:
    s_waitcnt vmcnt(6)
    s_waitcnt lgkmcnt(0)
    v_mfma_f32_32x32x16_bf16 v[8:23], v[104:107], v[112:115], v[8:23]
    ds_read_b64_tr_b16 v[72:73], v2 offset:12288
    ds_read_b64_tr_b16 v[74:75], v2 offset:12800
    s_add_u32 m0, s14, 0
    s_add_u32 s12, s12, 28672
    s_setprio 0
    buffer_load_dwordx4 v1, s[60:63], s12 offen lds
    s_setprio 3
    s_waitcnt lgkmcnt(1)
    v_mfma_f32_32x32x16_bf16 v[24:39], v[104:107], v[116:119], v[24:39]
    ds_read_b128 v[80:83], v4 offset:6336
    ds_read_b128 v[84:87], v7 offset:6336
    s_add_u32 m0, s14, 1024
    s_add_u32 s12, s12, 28672
    s_setprio 0
    buffer_load_dwordx4 v1, s[60:63], s12 offen lds
    s_setprio 3
    s_waitcnt vmcnt(6)
    s_waitcnt lgkmcnt(0)
    v_mfma_f32_32x32x16_bf16 v[8:23], v[72:75], v[80:83], v[8:23]
    ds_read_b64_tr_b16 v[88:89], v2 offset:14336
    ds_read_b64_tr_b16 v[90:91], v2 offset:14848
    s_add_u32 m0, s14, 2048
    s_add_u32 s12, s12, 28672
    s_setprio 0
    buffer_load_dwordx4 v1, s[60:63], s12 offen lds
    s_setprio 3
    s_waitcnt lgkmcnt(1)
    v_mfma_f32_32x32x16_bf16 v[24:39], v[72:75], v[84:87], v[24:39]
    ds_read_b128 v[96:99], v4 offset:7392
    ds_read_b128 v[100:103], v7 offset:7392
    s_add_u32 m0, s14, 3072
    s_add_u32 s12, s12, 28672
    s_setprio 0
    buffer_load_dwordx4 v1, s[60:63], s12 offen lds
    s_setprio 3
    s_add_u32 s6, s11, 1
    s_and_b32 s6, s6, 3
    s_mul_i32 s6, s6, 8448
    s_add_u32 s7, s6, 33792
    v_add_u32 v4, s6, v158
    v_add_u32 v7, s7, v158
    s_waitcnt vmcnt(6)
    s_waitcnt lgkmcnt(0)
    v_mfma_f32_32x32x16_bf16 v[8:23], v[88:91], v[96:99], v[8:23]
    ds_read_b64_tr_b16 v[104:105], v2 offset:16384
    ds_read_b64_tr_b16 v[106:107], v2 offset:16896
    s_add_u32 m0, s14, 4096
    s_add_u32 s12, s12, 28672
    s_setprio 0
    buffer_load_dwordx4 v1, s[60:63], s12 offen lds
    s_setprio 3
    s_waitcnt lgkmcnt(1)
    v_mfma_f32_32x32x16_bf16 v[24:39], v[88:91], v[100:103], v[24:39]
    ds_read_b128 v[112:115], v4 offset:0
    ds_read_b128 v[116:119], v7 offset:0
    s_add_u32 m0, s14, 5120
    s_add_u32 s12, s12, 28672
    s_setprio 0
    buffer_load_dwordx4 v1, s[60:63], s12 offen lds
    s_setprio 3
    s_waitcnt vmcnt(6)
    s_waitcnt lgkmcnt(0)
    v_mfma_f32_32x32x16_bf16 v[8:23], v[104:107], v[112:115], v[8:23]
    ds_read_b64_tr_b16 v[72:73], v2 offset:18432
    ds_read_b64_tr_b16 v[74:75], v2 offset:18944
    s_add_u32 m0, s14, 6144
    s_add_u32 s12, s12, 28672
    s_setprio 0
    buffer_load_dwordx4 v1, s[60:63], s12 offen lds
    s_setprio 3
    s_waitcnt lgkmcnt(1)
    v_mfma_f32_32x32x16_bf16 v[24:39], v[104:107], v[116:119], v[24:39]
    ds_read_b128 v[80:83], v4 offset:1056
    ds_read_b128 v[84:87], v7 offset:1056
    s_add_u32 m0, s14, 7168
    s_add_u32 s12, s12, 28672
    s_setprio 0
    buffer_load_dwordx4 v1, s[60:63], s12 offen lds
    s_setprio 3
    s_waitcnt vmcnt(6)
    s_waitcnt lgkmcnt(0)
    v_mfma_f32_32x32x16_bf16 v[8:23], v[72:75], v[80:83], v[8:23]
    ds_read_b64_tr_b16 v[88:89], v2 offset:0
    ds_read_b64_tr_b16 v[90:91], v2 offset:512
    s_add_u32 m0, s14, 8192
    s_add_u32 s12, s12, 28672
    s_setprio 0
    buffer_load_dwordx4 v1, s[60:63], s12 offen lds
    s_setprio 3
    s_waitcnt lgkmcnt(1)
    v_mfma_f32_32x32x16_bf16 v[24:39], v[72:75], v[84:87], v[24:39]
    ds_read_b128 v[96:99], v4 offset:2112
    ds_read_b128 v[100:103], v7 offset:2112
    s_add_u32 m0, s14, 9216
    s_add_u32 s12, s12, 28672
    s_setprio 0
    buffer_load_dwordx4 v1, s[60:63], s12 offen lds
    s_setprio 3
    s_waitcnt vmcnt(6)
    s_waitcnt lgkmcnt(0)
    v_mfma_f32_32x32x16_bf16 v[8:23], v[88:91], v[96:99], v[8:23]
    ds_read_b64_tr_b16 v[104:105], v2 offset:2048
    ds_read_b64_tr_b16 v[106:107], v2 offset:2560
    s_add_u32 m0, s14, 10240
    s_add_u32 s12, s12, 28672
    s_setprio 0
    buffer_load_dwordx4 v1, s[60:63], s12 offen lds
    s_setprio 3
    s_waitcnt lgkmcnt(1)
    v_mfma_f32_32x32x16_bf16 v[24:39], v[88:91], v[100:103], v[24:39]
    ds_read_b128 v[112:115], v4 offset:3168
    ds_read_b128 v[116:119], v7 offset:3168
    s_add_u32 m0, s14, 11264
    s_add_u32 s12, s12, 28672
    s_setprio 0
    buffer_load_dwordx4 v1, s[60:63], s12 offen lds
    s_setprio 3
    s_waitcnt vmcnt(6)
    s_waitcnt lgkmcnt(0)
    v_mfma_f32_32x32x16_bf16 v[8:23], v[104:107], v[112:115], v[8:23]
    ds_read_b64_tr_b16 v[72:73], v2 offset:4096
    ds_read_b64_tr_b16 v[74:75], v2 offset:4608
    s_cmp_eq_u32 s11, 2
    s_cselect_b32 s9, 1835008, 0
    s_sub_u32 s12, s12, s9
    s_add_u32 m0, s14, 12288
    s_add_u32 s12, s12, 28672
    s_setprio 0
    buffer_load_dwordx4 v1, s[60:63], s12 offen lds
    s_setprio 3
    s_waitcnt lgkmcnt(1)
    v_mfma_f32_32x32x16_bf16 v[24:39], v[104:107], v[116:119], v[24:39]
    ds_read_b128 v[80:83], v4 offset:4224
    ds_read_b128 v[84:87], v7 offset:4224
    s_add_u32 m0, s14, 13312
    s_add_u32 s12, s12, 28672
    s_setprio 0
    buffer_load_dwordx4 v1, s[60:63], s12 offen lds
    s_setprio 3
    s_waitcnt vmcnt(6)
    s_waitcnt lgkmcnt(0)
    v_mfma_f32_32x32x16_bf16 v[8:23], v[72:75], v[80:83], v[8:23]
    ds_read_b64_tr_b16 v[88:89], v2 offset:6144
    ds_read_b64_tr_b16 v[90:91], v2 offset:6656
    s_add_u32 m0, s14, 14336
    s_add_u32 s12, s12, 28672
    s_setprio 0
    buffer_load_dwordx4 v1, s[60:63], s12 offen lds
    s_setprio 3
    s_waitcnt lgkmcnt(1)
    v_mfma_f32_32x32x16_bf16 v[24:39], v[72:75], v[84:87], v[24:39]
    ds_read_b128 v[96:99], v4 offset:5280
    ds_read_b128 v[100:103], v7 offset:5280
    s_add_u32 m0, s14, 15360
    s_add_u32 s12, s12, 28672
    s_setprio 0
    buffer_load_dwordx4 v1, s[60:63], s12 offen lds
    s_setprio 3
    v_min_u32 v136, 55, v0
    v_lshlrev_b32 v136, 10, v136
    s_lshr_b32 s6, s2, 3
    s_mul_i32 s7, s6, 57344
    buffer_load_dword v6, v136, s[52:55], s7 offen offset:384
    v_and_b32 v136, 15, v0
    v_lshlrev_b32 v136, 10, v136
    s_lshl_b32 s7, s6, 14
    buffer_load_dword v6, v136, s[56:59], s7 offen offset:384
    s_waitcnt vmcnt(8)
    s_waitcnt lgkmcnt(0)
    v_mfma_f32_32x32x16_bf16 v[8:23], v[88:91], v[96:99], v[8:23]
    ds_read_b64_tr_b16 v[104:105], v2 offset:8192
    ds_read_b64_tr_b16 v[106:107], v2 offset:8704
    s_add_u32 m0, s14, 16384
    s_add_u32 s12, s12, 28672
    s_setprio 0
    buffer_load_dwordx4 v1, s[60:63], s12 offen lds
    s_setprio 3
    s_waitcnt lgkmcnt(1)
    v_mfma_f32_32x32x16_bf16 v[24:39], v[88:91], v[100:103], v[24:39]
    ds_read_b128 v[112:115], v4 offset:6336
    ds_read_b128 v[116:119], v7 offset:6336
    s_add_u32 m0, s14, 17408
    s_add_u32 s12, s12, 28672
    s_setprio 0
    buffer_load_dwordx4 v1, s[60:63], s12 offen lds
    s_setprio 3
    s_waitcnt vmcnt(8)
    s_waitcnt lgkmcnt(0)
    v_mfma_f32_32x32x16_bf16 v[8:23], v[104:107], v[112:115], v[8:23]
    ds_read_b64_tr_b16 v[72:73], v2 offset:10240
    ds_read_b64_tr_b16 v[74:75], v2 offset:10752
    s_add_u32 m0, s14, 18432
    s_add_u32 s12, s12, 28672
    s_setprio 0
    buffer_load_dwordx4 v1, s[60:63], s12 offen lds
    s_setprio 3
    s_waitcnt lgkmcnt(1)
    v_mfma_f32_32x32x16_bf16 v[24:39], v[104:107], v[116:119], v[24:39]
    ds_read_b128 v[80:83], v4 offset:7392
    ds_read_b128 v[84:87], v7 offset:7392
    s_add_u32 m0, s14, 19456
    s_add_u32 s12, s12, 28672
    s_setprio 0
    buffer_load_dwordx4 v1, s[60:63], s12 offen lds
    s_setprio 3
    s_add_u32 s6, s11, 2
    s_and_b32 s6, s6, 3
    s_mul_i32 s6, s6, 8448
    s_add_u32 s7, s6, 33792
    v_add_u32 v4, s6, v158
    v_add_u32 v7, s7, v158
    s_waitcnt vmcnt(8)
    s_waitcnt lgkmcnt(0)
    v_mfma_f32_32x32x16_bf16 v[8:23], v[72:75], v[80:83], v[8:23]
    ds_read_b64_tr_b16 v[88:89], v2 offset:12288
    ds_read_b64_tr_b16 v[90:91], v2 offset:12800
    s_add_u32 m0, s14, 0
    s_add_u32 s12, s12, 28672
    s_setprio 0
    buffer_load_dwordx4 v1, s[60:63], s12 offen lds
    s_setprio 3
    s_waitcnt lgkmcnt(1)
    v_mfma_f32_32x32x16_bf16 v[24:39], v[72:75], v[84:87], v[24:39]
    ds_read_b128 v[96:99], v4 offset:0
    ds_read_b128 v[100:103], v7 offset:0
    s_add_u32 m0, s14, 1024
    s_add_u32 s12, s12, 28672
    s_setprio 0
    buffer_load_dwordx4 v1, s[60:63], s12 offen lds
    s_setprio 3
    s_waitcnt vmcnt(8)
    s_waitcnt lgkmcnt(0)
    v_mfma_f32_32x32x16_bf16 v[8:23], v[88:91], v[96:99], v[8:23]
    ds_read_b64_tr_b16 v[104:105], v2 offset:14336
    ds_read_b64_tr_b16 v[106:107], v2 offset:14848
    s_add_u32 m0, s14, 2048
    s_add_u32 s12, s12, 28672
    s_setprio 0
    buffer_load_dwordx4 v1, s[60:63], s12 offen lds
    s_setprio 3
    s_waitcnt lgkmcnt(1)
    v_mfma_f32_32x32x16_bf16 v[24:39], v[88:91], v[100:103], v[24:39]
    ds_read_b128 v[112:115], v4 offset:1056
    ds_read_b128 v[116:119], v7 offset:1056
    s_add_u32 m0, s14, 3072
    s_add_u32 s12, s12, 28672
    s_setprio 0
    buffer_load_dwordx4 v1, s[60:63], s12 offen lds
    s_setprio 3
    s_waitcnt vmcnt(6)
    s_waitcnt lgkmcnt(0)
    v_mfma_f32_32x32x16_bf16 v[8:23], v[104:107], v[112:115], v[8:23]
    ds_read_b64_tr_b16 v[72:73], v2 offset:16384
    ds_read_b64_tr_b16 v[74:75], v2 offset:16896
    s_add_u32 m0, s14, 4096
    s_add_u32 s12, s12, 28672
    s_setprio 0
    buffer_load_dwordx4 v1, s[60:63], s12 offen lds
    s_setprio 3
    s_waitcnt lgkmcnt(1)
    v_mfma_f32_32x32x16_bf16 v[24:39], v[104:107], v[116:119], v[24:39]
    ds_read_b128 v[80:83], v4 offset:2112
    ds_read_b128 v[84:87], v7 offset:2112
    s_add_u32 m0, s14, 5120
    s_add_u32 s12, s12, 28672
    s_setprio 0
    buffer_load_dwordx4 v1, s[60:63], s12 offen lds
    s_setprio 3
    s_waitcnt vmcnt(6)
    s_waitcnt lgkmcnt(0)
    v_mfma_f32_32x32x16_bf16 v[8:23], v[72:75], v[80:83], v[8:23]
    ds_read_b64_tr_b16 v[88:89], v2 offset:18432
    ds_read_b64_tr_b16 v[90:91], v2 offset:18944
    s_add_u32 m0, s14, 6144
    s_add_u32 s12, s12, 28672
    s_setprio 0
    buffer_load_dwordx4 v1, s[60:63], s12 offen lds
    s_setprio 3
    s_waitcnt lgkmcnt(1)
    v_mfma_f32_32x32x16_bf16 v[24:39], v[72:75], v[84:87], v[24:39]
    ds_read_b128 v[96:99], v4 offset:3168
    ds_read_b128 v[100:103], v7 offset:3168
    s_add_u32 m0, s14, 7168
    s_add_u32 s12, s12, 28672
    s_setprio 0
    buffer_load_dwordx4 v1, s[60:63], s12 offen lds
    s_setprio 3
    s_waitcnt vmcnt(6)
    s_waitcnt lgkmcnt(0)
    v_mfma_f32_32x32x16_bf16 v[8:23], v[88:91], v[96:99], v[8:23]
    ds_read_b64_tr_b16 v[104:105], v2 offset:0
    ds_read_b64_tr_b16 v[106:107], v2 offset:512
    s_cmp_eq_u32 s11, 1
    s_cselect_b32 s9, 1835008, 0
    s_sub_u32 s12, s12, s9
    s_add_u32 m0, s14, 8192
    s_add_u32 s12, s12, 28672
    s_setprio 0
    buffer_load_dwordx4 v1, s[60:63], s12 offen lds
    s_setprio 3
    s_waitcnt lgkmcnt(1)
    v_mfma_f32_32x32x16_bf16 v[24:39], v[88:91], v[100:103], v[24:39]
    ds_read_b128 v[112:115], v4 offset:4224
    ds_read_b128 v[116:119], v7 offset:4224
    s_add_u32 m0, s14, 9216
    s_add_u32 s12, s12, 28672
    s_setprio 0
    buffer_load_dwordx4 v1, s[60:63], s12 offen lds
    s_setprio 3
    s_waitcnt vmcnt(6)
    s_waitcnt lgkmcnt(0)
    v_mfma_f32_32x32x16_bf16 v[8:23], v[104:107], v[112:115], v[8:23]
    ds_read_b64_tr_b16 v[72:73], v2 offset:2048
    ds_read_b64_tr_b16 v[74:75], v2 offset:2560
    s_add_u32 m0, s14, 10240
    s_add_u32 s12, s12, 28672
    s_setprio 0
    buffer_load_dwordx4 v1, s[60:63], s12 offen lds
    s_setprio 3
    s_waitcnt lgkmcnt(1)
    v_mfma_f32_32x32x16_bf16 v[24:39], v[104:107], v[116:119], v[24:39]
    ds_read_b128 v[80:83], v4 offset:5280
    ds_read_b128 v[84:87], v7 offset:5280
    s_add_u32 m0, s14, 11264
    s_add_u32 s12, s12, 28672
    s_setprio 0
    buffer_load_dwordx4 v1, s[60:63], s12 offen lds
    s_setprio 3
    s_lshl_b32 s6, s5, 6
    s_lshl2_add_u32 s6, s4, s6
    s_add_u32 s6, s6, s10
    s_lshl_b32 s6, s6, 10
    s_add_u32 s6, s6, 3145728
    s_add_u32 s7, s6, 32768
    v_mov_b32 v140, -1
    v_mov_b32 v141, -1
    v_mov_b32 v142, -1
    v_mov_b32 v143, -1
    s_cmp_lg_u32 s70, 0
    s_cbranch_scc0 L_thr_79
    buffer_store_dwordx4 v[140:143], v161, s[48:51], s6 offen
    s_branch L_std_80
L_thr_79:
    buffer_store_dwordx4 v[140:143], v161, s[48:51], s6 offen sc1
L_std_80:
    s_cmp_lg_u32 s70, 0
    s_cbranch_scc0 L_thr_81
    buffer_store_dwordx4 v[140:143], v161, s[48:51], s7 offen
    s_branch L_std_82
L_thr_81:
    buffer_store_dwordx4 v[140:143], v161, s[48:51], s7 offen sc1
L_std_82:
    s_waitcnt vmcnt(8)
    s_waitcnt lgkmcnt(0)
    v_mfma_f32_32x32x16_bf16 v[8:23], v[72:75], v[80:83], v[8:23]
    ds_read_b64_tr_b16 v[88:89], v2 offset:4096
    ds_read_b64_tr_b16 v[90:91], v2 offset:4608
    s_add_u32 m0, s14, 12288
    s_add_u32 s12, s12, 28672
    s_setprio 0
    buffer_load_dwordx4 v1, s[60:63], s12 offen lds
    s_setprio 3
    s_waitcnt lgkmcnt(1)
    v_mfma_f32_32x32x16_bf16 v[24:39], v[72:75], v[84:87], v[24:39]
    ds_read_b128 v[96:99], v4 offset:6336
    ds_read_b128 v[100:103], v7 offset:6336
    s_add_u32 m0, s14, 13312
    s_add_u32 s12, s12, 28672
    s_setprio 0
    buffer_load_dwordx4 v1, s[60:63], s12 offen lds
    s_setprio 3
    s_waitcnt vmcnt(8)
    s_waitcnt lgkmcnt(0)
    v_mfma_f32_32x32x16_bf16 v[8:23], v[88:91], v[96:99], v[8:23]
    ds_read_b64_tr_b16 v[104:105], v2 offset:6144
    ds_read_b64_tr_b16 v[106:107], v2 offset:6656
    s_add_u32 m0, s14, 14336
    s_add_u32 s12, s12, 28672
    s_setprio 0
    buffer_load_dwordx4 v1, s[60:63], s12 offen lds
    s_setprio 3
    s_waitcnt lgkmcnt(1)
    v_mfma_f32_32x32x16_bf16 v[24:39], v[88:91], v[100:103], v[24:39]
    ds_read_b128 v[112:115], v4 offset:7392
    ds_read_b128 v[116:119], v7 offset:7392
    s_add_u32 m0, s14, 15360
    s_add_u32 s12, s12, 28672
    s_setprio 0
    buffer_load_dwordx4 v1, s[60:63], s12 offen lds
    s_setprio 3
    s_add_u32 s6, s11, 3
    s_and_b32 s6, s6, 3
    s_mul_i32 s6, s6, 8448
    s_add_u32 s7, s6, 33792
    v_add_u32 v4, s6, v158
    v_add_u32 v7, s7, v158
    s_waitcnt vmcnt(8)
    s_waitcnt lgkmcnt(0)
    v_mfma_f32_32x32x16_bf16 v[8:23], v[104:107], v[112:115], v[8:23]
    ds_read_b64_tr_b16 v[72:73], v2 offset:8192
    ds_read_b64_tr_b16 v[74:75], v2 offset:8704
    s_add_u32 m0, s14, 16384
    s_add_u32 s12, s12, 28672
    s_setprio 0
    buffer_load_dwordx4 v1, s[60:63], s12 offen lds
    s_setprio 3
    s_waitcnt lgkmcnt(1)
    v_mfma_f32_32x32x16_bf16 v[24:39], v[104:107], v[116:119], v[24:39]
    ds_read_b128 v[80:83], v4 offset:0
    ds_read_b128 v[84:87], v7 offset:0
    s_add_u32 m0, s14, 17408
    s_add_u32 s12, s12, 28672
    s_setprio 0
    buffer_load_dwordx4 v1, s[60:63], s12 offen lds
    s_setprio 3
    s_waitcnt vmcnt(8)
    s_waitcnt lgkmcnt(0)
    v_mfma_f32_32x32x16_bf16 v[8:23], v[72:75], v[80:83], v[8:23]
    ds_read_b64_tr_b16 v[88:89], v2 offset:10240
    ds_read_b64_tr_b16 v[90:91], v2 offset:10752
    s_add_u32 m0, s14, 18432
    s_add_u32 s12, s12, 28672
    s_setprio 0
    buffer_load_dwordx4 v1, s[60:63], s12 offen lds
    s_setprio 3
    s_waitcnt lgkmcnt(1)
    v_mfma_f32_32x32x16_bf16 v[24:39], v[72:75], v[84:87], v[24:39]
    ds_read_b128 v[96:99], v4 offset:1056
    ds_read_b128 v[100:103], v7 offset:1056
    s_add_u32 m0, s14, 19456
    s_add_u32 s12, s12, 28672
    s_setprio 0
    buffer_load_dwordx4 v1, s[60:63], s12 offen lds
    s_setprio 3
    s_waitcnt vmcnt(6)
    s_waitcnt lgkmcnt(0)
    v_mfma_f32_32x32x16_bf16 v[8:23], v[88:91], v[96:99], v[8:23]
    ds_read_b64_tr_b16 v[104:105], v2 offset:12288
    ds_read_b64_tr_b16 v[106:107], v2 offset:12800
    s_add_u32 m0, s14, 0
    s_add_u32 s12, s12, 28672
    s_setprio 0
    buffer_load_dwordx4 v1, s[60:63], s12 offen lds
    s_setprio 3
    s_waitcnt lgkmcnt(1)
    v_mfma_f32_32x32x16_bf16 v[24:39], v[88:91], v[100:103], v[24:39]
    ds_read_b128 v[112:115], v4 offset:2112
    ds_read_b128 v[116:119], v7 offset:2112
    s_add_u32 m0, s14, 1024
    s_add_u32 s12, s12, 28672
    s_setprio 0
    buffer_load_dwordx4 v1, s[60:63], s12 offen lds
    s_setprio 3
    s_waitcnt vmcnt(6)
    s_waitcnt lgkmcnt(0)
    v_mfma_f32_32x32x16_bf16 v[8:23], v[104:107], v[112:115], v[8:23]
    ds_read_b64_tr_b16 v[72:73], v2 offset:14336
    ds_read_b64_tr_b16 v[74:75], v2 offset:14848
    s_add_u32 m0, s14, 2048
    s_add_u32 s12, s12, 28672
    s_setprio 0
    buffer_load_dwordx4 v1, s[60:63], s12 offen lds
    s_setprio 3
    s_waitcnt lgkmcnt(1)
    v_mfma_f32_32x32x16_bf16 v[24:39], v[104:107], v[116:119], v[24:39]
    ds_read_b128 v[80:83], v4 offset:3168
    ds_read_b128 v[84:87], v7 offset:3168
    s_add_u32 m0, s14, 3072
    s_add_u32 s12, s12, 28672
    s_setprio 0
    buffer_load_dwordx4 v1, s[60:63], s12 offen lds
    s_setprio 3
    s_waitcnt vmcnt(6)
    s_waitcnt lgkmcnt(0)
    v_mfma_f32_32x32x16_bf16 v[8:23], v[72:75], v[80:83], v[8:23]
    ds_read_b64_tr_b16 v[88:89], v2 offset:16384
    ds_read_b64_tr_b16 v[90:91], v2 offset:16896
    s_bfe_u32 s93, s88, 0x50000
    s_lshl_b32 s93, s93, 14
    s_add_u32 m0, s14, 4096
    s_add_u32 s93, s93, s68
    s_setprio 0
    buffer_load_dwordx4 v160, s[52:55], s93 offen lds
    s_setprio 3
    s_add_u32 m0, s14, 5120
    s_add_u32 s93, s93, 8192
    s_setprio 0
    buffer_load_dwordx4 v160, s[52:55], s93 offen lds
    s_setprio 3
    s_waitcnt lgkmcnt(1)
    v_mfma_f32_32x32x16_bf16 v[24:39], v[72:75], v[84:87], v[24:39]
    ds_read_b128 v[96:99], v4 offset:4224
    ds_read_b128 v[100:103], v7 offset:4224
    s_bfe_u32 s93, s88, 0x50005
    s_lshl_b32 s93, s93, 14
    s_add_u32 m0, s14, 6144
    s_add_u32 s93, s93, s68
    s_setprio 0
    buffer_load_dwordx4 v160, s[52:55], s93 offen lds
    s_setprio 3
    s_add_u32 m0, s14, 7168
    s_add_u32 s93, s93, 8192
    s_setprio 0
    buffer_load_dwordx4 v160, s[52:55], s93 offen lds
    s_setprio 3
    s_waitcnt vmcnt(8)
    s_waitcnt lgkmcnt(0)
    v_mfma_f32_32x32x16_bf16 v[8:23], v[88:91], v[96:99], v[8:23]
    ds_read_b64_tr_b16 v[104:105], v2 offset:18432
    ds_read_b64_tr_b16 v[106:107], v2 offset:18944
    s_bfe_u32 s93, s88, 0x5000a
    s_lshl_b32 s93, s93, 14
    s_add_u32 m0, s14, 8192
    s_add_u32 s93, s93, s68
    s_setprio 0
    buffer_load_dwordx4 v160, s[52:55], s93 offen lds
    s_setprio 3
    s_add_u32 m0, s14, 9216
    s_add_u32 s93, s93, 8192
    s_setprio 0
    buffer_load_dwordx4 v160, s[52:55], s93 offen lds
    s_setprio 3
    s_waitcnt lgkmcnt(1)
    v_mfma_f32_32x32x16_bf16 v[24:39], v[88:91], v[100:103], v[24:39]
    ds_read_b128 v[112:115], v4 offset:5280
    ds_read_b128 v[116:119], v7 offset:5280
    s_bfe_u32 s93, s88, 0x5000f
    s_lshl_b32 s93, s93, 14
    s_add_u32 m0, s14, 10240
    s_add_u32 s93, s93, s68
    s_setprio 0
    buffer_load_dwordx4 v160, s[52:55], s93 offen lds
    s_setprio 3
    s_add_u32 m0, s14, 11264
    s_add_u32 s93, s93, 8192
    s_setprio 0
    buffer_load_dwordx4 v160, s[52:55], s93 offen lds
    s_setprio 3
    s_waitcnt vmcnt(10)
    s_waitcnt lgkmcnt(0)
    v_mfma_f32_32x32x16_bf16 v[8:23], v[104:107], v[112:115], v[8:23]
    ds_read_b64_tr_b16 v[72:73], v2 offset:0
    ds_read_b64_tr_b16 v[74:75], v2 offset:512
    s_bfe_u32 s93, s88, 0x50014
    s_lshl_b32 s93, s93, 14
    s_add_u32 m0, s14, 12288
    s_add_u32 s93, s93, s68
    s_setprio 0
    buffer_load_dwordx4 v160, s[52:55], s93 offen lds
    s_setprio 3
    s_add_u32 m0, s14, 13312
    s_add_u32 s93, s93, 8192
    s_setprio 0
    buffer_load_dwordx4 v160, s[52:55], s93 offen lds
    s_setprio 3
    s_waitcnt lgkmcnt(1)
    v_mfma_f32_32x32x16_bf16 v[24:39], v[104:107], v[116:119], v[24:39]
    ds_read_b128 v[80:83], v4 offset:6336
    ds_read_b128 v[84:87], v7 offset:6336
    s_bfe_u32 s93, s88, 0x50019
    s_lshl_b32 s93, s93, 14
    s_add_u32 m0, s14, 14336
    s_add_u32 s93, s93, s68
    s_setprio 0
    buffer_load_dwordx4 v160, s[52:55], s93 offen lds
    s_setprio 3
    s_add_u32 m0, s14, 15360
    s_add_u32 s93, s93, 8192
    s_setprio 0
    buffer_load_dwordx4 v160, s[52:55], s93 offen lds
    s_setprio 3
    s_waitcnt vmcnt(12)
    s_waitcnt lgkmcnt(0)
    v_mfma_f32_32x32x16_bf16 v[8:23], v[72:75], v[80:83], v[8:23]
    ds_read_b64_tr_b16 v[88:89], v2 offset:2048
    ds_read_b64_tr_b16 v[90:91], v2 offset:2560
    s_bfe_u32 s93, s89, 0x50000
    s_lshl_b32 s93, s93, 14
    s_add_u32 m0, s14, 16384
    s_add_u32 s93, s93, s68
    s_setprio 0
    buffer_load_dwordx4 v160, s[52:55], s93 offen lds
    s_setprio 3
    s_add_u32 m0, s14, 17408
    s_add_u32 s93, s93, 8192
    s_setprio 0
    buffer_load_dwordx4 v160, s[52:55], s93 offen lds
    s_setprio 3
    s_waitcnt lgkmcnt(1)
    v_mfma_f32_32x32x16_bf16 v[24:39], v[72:75], v[84:87], v[24:39]
    ds_read_b128 v[96:99], v4 offset:7392
    ds_read_b128 v[100:103], v7 offset:7392
    s_bfe_u32 s93, s89, 0x50005
    s_lshl_b32 s93, s93, 14
    s_add_u32 m0, s14, 18432
    s_add_u32 s93, s93, s68
    s_setprio 0
    buffer_load_dwordx4 v160, s[52:55], s93 offen lds
    s_setprio 3
    s_add_u32 m0, s14, 19456
    s_add_u32 s93, s93, 8192
    s_setprio 0
    buffer_load_dwordx4 v160, s[52:55], s93 offen lds
    s_setprio 3
    s_waitcnt lgkmcnt(0)
    v_mfma_f32_32x32x16_bf16 v[8:23], v[88:91], v[96:99], v[8:23]
    s_bfe_u32 s93, s89, 0x5000a
    s_lshl_b32 s93, s93, 14
    s_add_u32 m0, s14, 0
    s_add_u32 s93, s93, s68
    s_setprio 0
    buffer_load_dwordx4 v160, s[52:55], s93 offen lds
    s_setprio 3
    s_add_u32 m0, s14, 1024
    s_add_u32 s93, s93, 8192
    s_setprio 0
    buffer_load_dwordx4 v160, s[52:55], s93 offen lds
    s_setprio 3
    v_mfma_f32_32x32x16_bf16 v[24:39], v[88:91], v[100:103], v[24:39]
    s_bfe_u32 s93, s89, 0x5000f
    s_lshl_b32 s93, s93, 14
    s_add_u32 m0, s14, 2048
    s_add_u32 s93, s93, s68
    s_setprio 0
    buffer_load_dwordx4 v160, s[52:55], s93 offen lds
    s_setprio 3
    s_add_u32 m0, s14, 3072
    s_add_u32 s93, s93, 8192
    s_setprio 0
    buffer_load_dwordx4 v160, s[52:55], s93 offen lds
    s_setprio 3
    s_setprio 3
    s_mov_b64 exec, 1
    ds_add_u32 v164, v165 offset:24
    s_mov_b64 exec, -1
    v_mov_b32 v158, s43
    v_bfe_u32 v7, v0, 4, 1
    v_mul_u32_u24 v7, 114688, v7
    v_and_b32 v4, 15, v0
    v_lshl_add_u32 v7, v4, 7, v7
    s_mov_b32 s64, 0xbdd2d3e8
    s_mov_b32 s65, 0xbdd2d3e8
    s_mov_b32 s66, 1.0
    s_mov_b32 s67, 1.0
    v_mov_b32 v156, 0xc0135761
    v_mov_b32 v157, 0xc0135761
    s_lshl_b32 s6, s5, 1
    s_mul_i32 s6, s6, 112
    s_lshr_b32 s7, s13, 5
    s_add_u32 s6, s6, s7
    s_lshl_b32 s6, s6, 10
    s_add_u32 s6, s6, 5242880
    s_add_u32 s7, s6, 114688
    v_lshlrev_b32 v136, 16, v120
    v_and_b32 v137, 0xffff0000, v120
    v_lshlrev_b32 v138, 16, v121
    v_and_b32 v139, 0xffff0000, v121
    v_lshlrev_b32 v140, 16, v122
    v_and_b32 v141, 0xffff0000, v122
    v_lshlrev_b32 v142, 16, v123
    v_and_b32 v143, 0xffff0000, v123
    v_lshlrev_b32 v144, 16, v124
    v_and_b32 v145, 0xffff0000, v124
    v_lshlrev_b32 v146, 16, v125
    v_and_b32 v147, 0xffff0000, v125
    v_lshlrev_b32 v148, 16, v126
    v_and_b32 v149, 0xffff0000, v126
    v_lshlrev_b32 v150, 16, v127
    v_and_b32 v151, 0xffff0000, v127
    v_pk_fma_f32 v[8:9], v[8:9], v[152:153], v[136:137] op_sel_hi:[1,0,1]
    v_pk_fma_f32 v[10:11], v[10:11], v[152:153], v[138:139] op_sel_hi:[1,0,1]
    v_pk_fma_f32 v[12:13], v[12:13], v[152:153], v[140:141] op_sel_hi:[1,0,1]
    v_pk_fma_f32 v[14:15], v[14:15], v[152:153], v[142:143] op_sel_hi:[1,0,1]
    v_pk_mul_f32 v[72:73], v[8:9], v[8:9]
    v_pk_mul_f32 v[74:75], v[10:11], v[10:11]
    v_pk_mul_f32 v[76:77], v[12:13], v[12:13]
    v_pk_mul_f32 v[78:79], v[14:15], v[14:15]
    v_pk_fma_f32 v[72:73], v[72:73], s[64:65], v[156:157]
    v_pk_fma_f32 v[74:75], v[74:75], s[64:65], v[156:157]
    v_pk_fma_f32 v[76:77], v[76:77], s[64:65], v[156:157]
    v_pk_fma_f32 v[78:79], v[78:79], s[64:65], v[156:157]
    v_pk_mul_f32 v[72:73], v[72:73], v[8:9]
    v_pk_mul_f32 v[74:75], v[74:75], v[10:11]
    v_pk_mul_f32 v[76:77], v[76:77], v[12:13]
    v_pk_mul_f32 v[78:79], v[78:79], v[14:15]
    v_exp_f32 v72, v72
    v_exp_f32 v74, v74
    v_exp_f32 v76, v76
    v_exp_f32 v78, v78
    v_exp_f32 v73, v73
    v_exp_f32 v75, v75
    v_exp_f32 v77, v77
    v_exp_f32 v79, v79
    v_pk_add_f32 v[72:73], v[72:73], s[66:67]
    v_pk_add_f32 v[74:75], v[74:75], s[66:67]
    v_pk_add_f32 v[76:77], v[76:77], s[66:67]
    v_pk_add_f32 v[78:79], v[78:79], s[66:67]
    v_rcp_f32 v72, v72
    v_rcp_f32 v74, v74
    v_rcp_f32 v76, v76
    v_rcp_f32 v78, v78
    v_rcp_f32 v73, v73
    v_rcp_f32 v75, v75
    v_rcp_f32 v77, v77
    v_rcp_f32 v79, v79
    v_pk_mul_f32 v[72:73], v[72:73], v[8:9]
    v_pk_mul_f32 v[74:75], v[74:75], v[10:11]
    v_pk_mul_f32 v[76:77], v[76:77], v[12:13]
    v_pk_mul_f32 v[78:79], v[78:79], v[14:15]
    v_cvt_pk_bf16_f32 v80, v72, v73
    v_cvt_pk_bf16_f32 v81, v74, v75
    v_cvt_pk_bf16_f32 v82, v76, v77
    v_cvt_pk_bf16_f32 v83, v78, v79
    s_cmp_lg_u32 s70, 0
    s_cbranch_scc0 L_thr_83
    buffer_store_dwordx4 v[80:83], v161, s[48:51], s6 offen offset:0
    s_branch L_std_84
L_thr_83:
    buffer_store_dwordx4 v[80:83], v161, s[48:51], s6 offen offset:0 sc1
L_std_84:
    v_pk_fma_f32 v[16:17], v[16:17], v[152:153], v[144:145] op_sel_hi:[1,0,1]
    v_pk_fma_f32 v[18:19], v[18:19], v[152:153], v[146:147] op_sel_hi:[1,0,1]
    v_pk_fma_f32 v[20:21], v[20:21], v[152:153], v[148:149] op_sel_hi:[1,0,1]
    v_pk_fma_f32 v[22:23], v[22:23], v[152:153], v[150:151] op_sel_hi:[1,0,1]
    v_pk_mul_f32 v[72:73], v[16:17], v[16:17]
    v_pk_mul_f32 v[74:75], v[18:19], v[18:19]
    v_pk_mul_f32 v[76:77], v[20:21], v[20:21]
    v_pk_mul_f32 v[78:79], v[22:23], v[22:23]
    v_pk_fma_f32 v[72:73], v[72:73], s[64:65], v[156:157]
    v_pk_fma_f32 v[74:75], v[74:75], s[64:65], v[156:157]
    v_pk_fma_f32 v[76:77], v[76:77], s[64:65], v[156:157]
    v_pk_fma_f32 v[78:79], v[78:79], s[64:65], v[156:157]
    v_pk_mul_f32 v[72:73], v[72:73], v[16:17]
    v_pk_mul_f32 v[74:75], v[74:75], v[18:19]
    v_pk_mul_f32 v[76:77], v[76:77], v[20:21]
    v_pk_mul_f32 v[78:79], v[78:79], v[22:23]
    v_exp_f32 v72, v72
    v_exp_f32 v74, v74
    v_exp_f32 v76, v76
    v_exp_f32 v78, v78
    v_exp_f32 v73, v73
    v_exp_f32 v75, v75
    v_exp_f32 v77, v77
    v_exp_f32 v79, v79
    v_pk_add_f32 v[72:73], v[72:73], s[66:67]
    v_pk_add_f32 v[74:75], v[74:75], s[66:67]
    v_pk_add_f32 v[76:77], v[76:77], s[66:67]
    v_pk_add_f32 v[78:79], v[78:79], s[66:67]
    v_rcp_f32 v72, v72
    v_rcp_f32 v74, v74
    v_rcp_f32 v76, v76
    v_rcp_f32 v78, v78
    v_rcp_f32 v73, v73
    v_rcp_f32 v75, v75
    v_rcp_f32 v77, v77
    v_rcp_f32 v79, v79
    v_pk_mul_f32 v[72:73], v[72:73], v[16:17]
    v_pk_mul_f32 v[74:75], v[74:75], v[18:19]
    v_pk_mul_f32 v[76:77], v[76:77], v[20:21]
    v_pk_mul_f32 v[78:79], v[78:79], v[22:23]
    v_cvt_pk_bf16_f32 v84, v72, v73
    v_cvt_pk_bf16_f32 v85, v74, v75
    v_cvt_pk_bf16_f32 v86, v76, v77
    v_cvt_pk_bf16_f32 v87, v78, v79
    s_cmp_lg_u32 s70, 0
    s_cbranch_scc0 L_thr_85
    buffer_store_dwordx4 v[84:87], v161, s[48:51], s6 offen offset:1024
    s_branch L_std_86
L_thr_85:
    buffer_store_dwordx4 v[84:87], v161, s[48:51], s6 offen offset:1024 sc1
L_std_86:
    v_pk_fma_f32 v[24:25], v[24:25], v[154:155], v[136:137] op_sel_hi:[1,0,1]
    v_pk_fma_f32 v[26:27], v[26:27], v[154:155], v[138:139] op_sel_hi:[1,0,1]
    v_pk_fma_f32 v[28:29], v[28:29], v[154:155], v[140:141] op_sel_hi:[1,0,1]
    v_pk_fma_f32 v[30:31], v[30:31], v[154:155], v[142:143] op_sel_hi:[1,0,1]
    v_pk_mul_f32 v[72:73], v[24:25], v[24:25]
    v_pk_mul_f32 v[74:75], v[26:27], v[26:27]
    v_pk_mul_f32 v[76:77], v[28:29], v[28:29]
    v_pk_mul_f32 v[78:79], v[30:31], v[30:31]
    v_pk_fma_f32 v[72:73], v[72:73], s[64:65], v[156:157]
    v_pk_fma_f32 v[74:75], v[74:75], s[64:65], v[156:157]
    v_pk_fma_f32 v[76:77], v[76:77], s[64:65], v[156:157]
    v_pk_fma_f32 v[78:79], v[78:79], s[64:65], v[156:157]
    v_pk_mul_f32 v[72:73], v[72:73], v[24:25]
    v_pk_mul_f32 v[74:75], v[74:75], v[26:27]
    v_pk_mul_f32 v[76:77], v[76:77], v[28:29]
    v_pk_mul_f32 v[78:79], v[78:79], v[30:31]
    v_exp_f32 v72, v72
    v_exp_f32 v74, v74
    v_exp_f32 v76, v76
    v_exp_f32 v78, v78
    v_exp_f32 v73, v73
    v_exp_f32 v75, v75
    v_exp_f32 v77, v77
    v_exp_f32 v79, v79
    v_pk_add_f32 v[72:73], v[72:73], s[66:67]
    v_pk_add_f32 v[74:75], v[74:75], s[66:67]
    v_pk_add_f32 v[76:77], v[76:77], s[66:67]
    v_pk_add_f32 v[78:79], v[78:79], s[66:67]
    v_rcp_f32 v72, v72
    v_rcp_f32 v74, v74
    v_rcp_f32 v76, v76
    v_rcp_f32 v78, v78
    v_rcp_f32 v73, v73
    v_rcp_f32 v75, v75
    v_rcp_f32 v77, v77
    v_rcp_f32 v79, v79
    v_pk_mul_f32 v[72:73], v[72:73], v[24:25]
    v_pk_mul_f32 v[74:75], v[74:75], v[26:27]
    v_pk_mul_f32 v[76:77], v[76:77], v[28:29]
    v_pk_mul_f32 v[78:79], v[78:79], v[30:31]
    v_cvt_pk_bf16_f32 v80, v72, v73
    v_cvt_pk_bf16_f32 v81, v74, v75
    v_cvt_pk_bf16_f32 v82, v76, v77
    v_cvt_pk_bf16_f32 v83, v78, v79
    s_cmp_lg_u32 s70, 0
    s_cbranch_scc0 L_thr_87
    buffer_store_dwordx4 v[80:83], v161, s[48:51], s7 offen offset:0
    s_branch L_std_88
L_thr_87:
    buffer_store_dwordx4 v[80:83], v161, s[48:51], s7 offen offset:0 sc1
L_std_88:
    v_pk_fma_f32 v[32:33], v[32:33], v[154:155], v[144:145] op_sel_hi:[1,0,1]
    v_pk_fma_f32 v[34:35], v[34:35], v[154:155], v[146:147] op_sel_hi:[1,0,1]
    v_pk_fma_f32 v[36:37], v[36:37], v[154:155], v[148:149] op_sel_hi:[1,0,1]
    v_pk_fma_f32 v[38:39], v[38:39], v[154:155], v[150:151] op_sel_hi:[1,0,1]
    v_pk_mul_f32 v[72:73], v[32:33], v[32:33]
    v_pk_mul_f32 v[74:75], v[34:35], v[34:35]
    v_pk_mul_f32 v[76:77], v[36:37], v[36:37]
    v_pk_mul_f32 v[78:79], v[38:39], v[38:39]
    v_pk_fma_f32 v[72:73], v[72:73], s[64:65], v[156:157]
    v_pk_fma_f32 v[74:75], v[74:75], s[64:65], v[156:157]
    v_pk_fma_f32 v[76:77], v[76:77], s[64:65], v[156:157]
    v_pk_fma_f32 v[78:79], v[78:79], s[64:65], v[156:157]
    v_pk_mul_f32 v[72:73], v[72:73], v[32:33]
    v_pk_mul_f32 v[74:75], v[74:75], v[34:35]
    v_pk_mul_f32 v[76:77], v[76:77], v[36:37]
    v_pk_mul_f32 v[78:79], v[78:79], v[38:39]
    v_exp_f32 v72, v72
    v_exp_f32 v74, v74
    v_exp_f32 v76, v76
    v_exp_f32 v78, v78
    v_exp_f32 v73, v73
    v_exp_f32 v75, v75
    v_exp_f32 v77, v77
    v_exp_f32 v79, v79
    v_pk_add_f32 v[72:73], v[72:73], s[66:67]
    v_pk_add_f32 v[74:75], v[74:75], s[66:67]
    v_pk_add_f32 v[76:77], v[76:77], s[66:67]
    v_pk_add_f32 v[78:79], v[78:79], s[66:67]
    v_rcp_f32 v72, v72
    v_rcp_f32 v74, v74
    v_rcp_f32 v76, v76
    v_rcp_f32 v78, v78
    v_rcp_f32 v73, v73
    v_rcp_f32 v75, v75
    v_rcp_f32 v77, v77
    v_rcp_f32 v79, v79
    v_pk_mul_f32 v[72:73], v[72:73], v[32:33]
    v_pk_mul_f32 v[74:75], v[74:75], v[34:35]
    v_pk_mul_f32 v[76:77], v[76:77], v[36:37]
    v_pk_mul_f32 v[78:79], v[78:79], v[38:39]
    v_cvt_pk_bf16_f32 v84, v72, v73
    v_cvt_pk_bf16_f32 v85, v74, v75
    v_cvt_pk_bf16_f32 v86, v76, v77
    v_cvt_pk_bf16_f32 v87, v78, v79
    s_cmp_lg_u32 s70, 0
    s_cbranch_scc0 L_thr_89
    buffer_store_dwordx4 v[84:87], v161, s[48:51], s7 offen offset:1024
    s_branch L_std_90
L_thr_89:
    buffer_store_dwordx4 v[84:87], v161, s[48:51], s7 offen offset:1024 sc1
L_std_90:
    s_waitcnt vmcnt(0)
    s_mov_b64 exec, 1
    s_cmp_lg_u32 s70, 0
    s_cbranch_scc0 L_thr_91
    buffer_store_dword v158, off, s[48:51], s79 offset:0
    s_branch L_std_92
L_thr_91:
    buffer_store_dword v158, off, s[48:51], s79 offset:0 sc1
L_std_92:
    s_mov_b64 exec, -1
    v_mov_b32 v4, 0x100
    s_mov_b64 exec, 1
    ds_add_u32 v164, v4 offset:24
    s_mov_b64 exec, -1
    s_mov_b32 s94, s6
    s_mov_b32 s95, s7
L_spin_93:
    ds_read_b32 v4, v164 offset:24
    s_waitcnt lgkmcnt(0)
    v_readfirstlane_b32 s6, v4
    s_nop 0
    s_bfe_u32 s7, s6, 0x80000
    s_cmp_ge_u32 s7, 4
    s_cbranch_scc1 L_spun_94
    s_sleep 1
    s_sub_u32 s86, s86, 1
    s_cbranch_scc0 L_spin_93
    s_mov_b32 s86, 0
L_spun_94:
    s_mov_b32 s6, s94
    s_mov_b32 s7, s95
    s_lshl_b32 s78, s10, 14
    s_sub_u32 s8, s14, s78
    v_subrev_u32 v5, s8, v162
    v_subrev_u32 v7, s8, v163
    s_bfe_u32 s93, s89, 0x50014
    s_lshl_b32 s93, s93, 14
    s_add_u32 m0, s78, 0
    s_add_u32 s93, s93, s68
    s_setprio 0
    buffer_load_dwordx4 v160, s[52:55], s93 offen lds
    s_setprio 3
    s_add_u32 m0, s78, 1024
    s_add_u32 s93, s93, 8192
    s_setprio 0
    buffer_load_dwordx4 v160, s[52:55], s93 offen lds
    s_setprio 3
    s_bfe_u32 s93, s89, 0x50019
    s_lshl_b32 s93, s93, 14
    s_add_u32 m0, s78, 2048
    s_add_u32 s93, s93, s68
    s_setprio 0
    buffer_load_dwordx4 v160, s[52:55], s93 offen lds
    s_setprio 3
    s_add_u32 m0, s78, 3072
    s_add_u32 s93, s93, 8192
    s_setprio 0
    buffer_load_dwordx4 v160, s[52:55], s93 offen lds
    s_setprio 3
    s_bfe_u32 s93, s90, 0x50000
    s_lshl_b32 s93, s93, 14
    s_add_u32 m0, s78, 4096
    s_add_u32 s93, s93, s68
    s_setprio 0
    buffer_load_dwordx4 v160, s[52:55], s93 offen lds
    s_setprio 3
    s_add_u32 m0, s78, 5120
    s_add_u32 s93, s93, 8192
    s_setprio 0
    buffer_load_dwordx4 v160, s[52:55], s93 offen lds
    s_setprio 3
    s_bfe_u32 s93, s90, 0x50005
    s_lshl_b32 s93, s93, 14
    s_add_u32 m0, s78, 6144
    s_add_u32 s93, s93, s68
    s_setprio 0
    buffer_load_dwordx4 v160, s[52:55], s93 offen lds
    s_setprio 3
    s_add_u32 m0, s78, 7168
    s_add_u32 s93, s93, 8192
    s_setprio 0
    buffer_load_dwordx4 v160, s[52:55], s93 offen lds
    s_setprio 3
    s_bfe_u32 s93, s90, 0x5000a
    s_lshl_b32 s93, s93, 14
    s_add_u32 m0, s78, 8192
    s_add_u32 s93, s93, s68
    s_setprio 0
    buffer_load_dwordx4 v160, s[52:55], s93 offen lds
    s_setprio 3
    s_add_u32 m0, s78, 9216
    s_add_u32 s93, s93, 8192
    s_setprio 0
    buffer_load_dwordx4 v160, s[52:55], s93 offen lds
    s_setprio 3
    s_bfe_u32 s93, s90, 0x5000f
    s_lshl_b32 s93, s93, 14
    s_add_u32 m0, s78, 10240
    s_add_u32 s93, s93, s68
    s_setprio 0
    buffer_load_dwordx4 v160, s[52:55], s93 offen lds
    s_setprio 3
    s_add_u32 m0, s78, 11264
    s_add_u32 s93, s93, 8192
    s_setprio 0
    buffer_load_dwordx4 v160, s[52:55], s93 offen lds
    s_setprio 3
    s_bfe_u32 s93, s90, 0x50014
    s_lshl_b32 s93, s93, 14
    s_add_u32 m0, s78, 12288
    s_add_u32 s93, s93, s68
    s_setprio 0
    buffer_load_dwordx4 v160, s[52:55], s93 offen lds
    s_setprio 3
    s_add_u32 m0, s78, 13312
    s_add_u32 s93, s93, 8192
    s_setprio 0
    buffer_load_dwordx4 v160, s[52:55], s93 offen lds
    s_setprio 3
    s_bfe_u32 s93, s90, 0x50019
    s_lshl_b32 s93, s93, 14
    s_add_u32 m0, s78, 14336
    s_add_u32 s93, s93, s68
    s_setprio 0
    buffer_load_dwordx4 v160, s[52:55], s93 offen lds
    s_setprio 3
    s_add_u32 m0, s78, 15360
    s_add_u32 s93, s93, 8192
    s_setprio 0
    buffer_load_dwordx4 v160, s[52:55], s93 offen lds
    s_setprio 3
L_spin_95:
    ds_read_b32 v4, v164 offset:24
    s_waitcnt lgkmcnt(0)
    v_readfirstlane_b32 s6, v4
    s_nop 0
    s_bfe_u32 s7, s6, 0x80010
    s_cmp_ge_u32 s7, 3
    s_cbranch_scc1 L_spun_96
    s_sleep 8
    s_sub_u32 s86, s86, 1
    s_cbranch_scc0 L_spin_95
    s_mov_b32 s86, 0
L_spun_96:
    buffer_load_dword v1, v159, s[48:51], s80 offen sc1
    s_waitcnt vmcnt(0)
L_f1e_48:
    v_cmp_ne_u32 vcc, s43, v1
    s_cbranch_vccz L_hok_98
L_hpoll_97:
    buffer_load_dword v1, v159, s[48:51], s80 offen sc1
    s_waitcnt vmcnt(0)
    v_cmp_ne_u32 vcc, s43, v1
    s_cbranch_vccz L_hok_98
    s_sleep 4
    s_sub_u32 s86, s86, 1
    s_cbranch_scc0 L_hpoll_97
    s_mov_b32 s86, 0
L_hok_98:
    s_bfe_u32 s94, s88, 0x50000
    s_lshl_b32 s94, s94, 10
    s_add_u32 s95, s94, s83
    s_add_u32 s94, s94, s82
    s_setprio 0
    buffer_load_dwordx4 v[88:91], v161, s[48:51], s94 offen nt
    s_setprio 3
    s_setprio 0
    buffer_load_dwordx4 v[92:95], v161, s[48:51], s95 offen nt
    s_setprio 3
    s_bfe_u32 s94, s88, 0x50005
    s_lshl_b32 s94, s94, 10
    s_add_u32 s95, s94, s83
    s_add_u32 s94, s94, s82
    s_setprio 0
    buffer_load_dwordx4 v[96:99], v161, s[48:51], s94 offen nt
    s_setprio 3
    s_setprio 0
    buffer_load_dwordx4 v[100:103], v161, s[48:51], s95 offen nt
    s_setprio 3
    s_bfe_u32 s94, s88, 0x5000a
    s_lshl_b32 s94, s94, 10
    s_add_u32 s95, s94, s83
    s_add_u32 s94, s94, s82
    s_setprio 0
    buffer_load_dwordx4 v[104:107], v161, s[48:51], s94 offen nt
    s_setprio 3
    s_setprio 0
    buffer_load_dwordx4 v[108:111], v161, s[48:51], s95 offen nt
    s_setprio 3
    ds_read_b64_tr_b16 v[72:73], v162 offset:4096
    ds_read_b64_tr_b16 v[74:75], v162 offset:5120
    ds_read_b64_tr_b16 v[76:77], v163 offset:4096
    ds_read_b64_tr_b16 v[78:79], v163 offset:5120
    s_setprio 0
    s_waitcnt vmcnt(4)
    s_waitcnt lgkmcnt(0)
    v_mfma_f32_32x32x16_bf16 v[8:23], v[72:75], v[88:91], 0
    ds_read_b64_tr_b16 v[80:81], v162 offset:6144
    ds_read_b64_tr_b16 v[82:83], v162 offset:7168
    v_mfma_f32_32x32x16_bf16 v[24:39], v[72:75], v[92:95], 0
    ds_read_b64_tr_b16 v[84:85], v163 offset:6144
    ds_read_b64_tr_b16 v[86:87], v163 offset:7168
    v_mfma_f32_32x32x16_bf16 v[40:55], v[76:79], v[88:91], 0
    s_bfe_u32 s94, s88, 0x5000f
    s_lshl_b32 s94, s94, 10
    s_add_u32 s95, s94, s83
    s_add_u32 s94, s94, s82
    buffer_load_dwordx4 v[112:115], v161, s[48:51], s94 offen nt
    v_mfma_f32_32x32x16_bf16 v[56:71], v[76:79], v[92:95], 0
    buffer_load_dwordx4 v[116:119], v161, s[48:51], s95 offen nt
    s_waitcnt vmcnt(4)
    s_waitcnt lgkmcnt(0)
    v_mfma_f32_32x32x16_bf16 v[8:23], v[80:83], v[96:99], v[8:23]
    ds_read_b64_tr_b16 v[72:73], v162 offset:8192
    ds_read_b64_tr_b16 v[74:75], v162 offset:9216
    v_mfma_f32_32x32x16_bf16 v[24:39], v[80:83], v[100:103], v[24:39]
    ds_read_b64_tr_b16 v[76:77], v163 offset:8192
    ds_read_b64_tr_b16 v[78:79], v163 offset:9216
    v_mfma_f32_32x32x16_bf16 v[40:55], v[84:87], v[96:99], v[40:55]
    s_bfe_u32 s94, s88, 0x50014
    s_lshl_b32 s94, s94, 10
    s_add_u32 s95, s94, s83
    s_add_u32 s94, s94, s82
    buffer_load_dwordx4 v[120:123], v161, s[48:51], s94 offen nt
    v_mfma_f32_32x32x16_bf16 v[56:71], v[84:87], v[100:103], v[56:71]
    buffer_load_dwordx4 v[124:127], v161, s[48:51], s95 offen nt
    s_waitcnt vmcnt(4)
    s_waitcnt lgkmcnt(0)
    v_mfma_f32_32x32x16_bf16 v[8:23], v[72:75], v[104:107], v[8:23]
    ds_read_b64_tr_b16 v[80:81], v162 offset:10240
    ds_read_b64_tr_b16 v[82:83], v162 offset:11264
    v_mfma_f32_32x32x16_bf16 v[24:39], v[72:75], v[108:111], v[24:39]
    ds_read_b64_tr_b16 v[84:85], v163 offset:10240
    ds_read_b64_tr_b16 v[86:87], v163 offset:11264
    v_mfma_f32_32x32x16_bf16 v[40:55], v[76:79], v[104:107], v[40:55]
    s_bfe_u32 s94, s88, 0x50019
    s_lshl_b32 s94, s94, 10
    s_add_u32 s95, s94, s83
    s_add_u32 s94, s94, s82
    buffer_load_dwordx4 v[128:131], v161, s[48:51], s94 offen nt
    v_mfma_f32_32x32x16_bf16 v[56:71], v[76:79], v[108:111], v[56:71]
    buffer_load_dwordx4 v[132:135], v161, s[48:51], s95 offen nt
    s_waitcnt vmcnt(4)
    s_waitcnt lgkmcnt(0)
    v_mfma_f32_32x32x16_bf16 v[8:23], v[80:83], v[112:115], v[8:23]
    ds_read_b64_tr_b16 v[72:73], v162 offset:12288
    ds_read_b64_tr_b16 v[74:75], v162 offset:13312
    v_mfma_f32_32x32x16_bf16 v[24:39], v[80:83], v[116:119], v[24:39]
    ds_read_b64_tr_b16 v[76:77], v163 offset:12288
    ds_read_b64_tr_b16 v[78:79], v163 offset:13312
    v_mfma_f32_32x32x16_bf16 v[40:55], v[84:87], v[112:115], v[40:55]
    s_bfe_u32 s94, s89, 0x50000
    s_lshl_b32 s94, s94, 10
    s_add_u32 s95, s94, s83
    s_add_u32 s94, s94, s82
    buffer_load_dwordx4 v[136:139], v161, s[48:51], s94 offen nt
    v_mfma_f32_32x32x16_bf16 v[56:71], v[84:87], v[116:119], v[56:71]
    buffer_load_dwordx4 v[140:143], v161, s[48:51], s95 offen nt
    s_waitcnt vmcnt(4)
    s_waitcnt lgkmcnt(0)
    v_mfma_f32_32x32x16_bf16 v[8:23], v[72:75], v[120:123], v[8:23]
    ds_read_b64_tr_b16 v[80:81], v162 offset:14336
    ds_read_b64_tr_b16 v[82:83], v162 offset:15360
    v_mfma_f32_32x32x16_bf16 v[24:39], v[72:75], v[124:127], v[24:39]
    ds_read_b64_tr_b16 v[84:85], v163 offset:14336
    ds_read_b64_tr_b16 v[86:87], v163 offset:15360
    v_mfma_f32_32x32x16_bf16 v[40:55], v[76:79], v[120:123], v[40:55]
    s_bfe_u32 s94, s89, 0x50005
    s_lshl_b32 s94, s94, 10
    s_add_u32 s95, s94, s83
    s_add_u32 s94, s94, s82
    buffer_load_dwordx4 v[144:147], v161, s[48:51], s94 offen nt
    v_mfma_f32_32x32x16_bf16 v[56:71], v[76:79], v[124:127], v[56:71]
    buffer_load_dwordx4 v[148:151], v161, s[48:51], s95 offen nt
    s_waitcnt vmcnt(4)
    s_waitcnt lgkmcnt(0)
    v_mfma_f32_32x32x16_bf16 v[8:23], v[80:83], v[128:131], v[8:23]
    ds_read_b64_tr_b16 v[72:73], v162 offset:16384
    ds_read_b64_tr_b16 v[74:75], v162 offset:17408
    v_mfma_f32_32x32x16_bf16 v[24:39], v[80:83], v[132:135], v[24:39]
    ds_read_b64_tr_b16 v[76:77], v163 offset:16384
    ds_read_b64_tr_b16 v[78:79], v163 offset:17408
    v_mfma_f32_32x32x16_bf16 v[40:55], v[84:87], v[128:131], v[40:55]
    s_bfe_u32 s94, s89, 0x5000a
    s_lshl_b32 s94, s94, 10
    s_add_u32 s95, s94, s83
    s_add_u32 s94, s94, s82
    buffer_load_dwordx4 v[88:91], v161, s[48:51], s94 offen nt
    v_mfma_f32_32x32x16_bf16 v[56:71], v[84:87], v[132:135], v[56:71]
    buffer_load_dwordx4 v[92:95], v161, s[48:51], s95 offen nt
    s_waitcnt vmcnt(4)
    s_waitcnt lgkmcnt(0)
    v_mfma_f32_32x32x16_bf16 v[8:23], v[72:75], v[136:139], v[8:23]
    ds_read_b64_tr_b16 v[80:81], v162 offset:18432
    ds_read_b64_tr_b16 v[82:83], v162 offset:19456
    v_mfma_f32_32x32x16_bf16 v[24:39], v[72:75], v[140:143], v[24:39]
    ds_read_b64_tr_b16 v[84:85], v163 offset:18432
    ds_read_b64_tr_b16 v[86:87], v163 offset:19456
    v_mfma_f32_32x32x16_bf16 v[40:55], v[76:79], v[136:139], v[40:55]
    s_bfe_u32 s94, s89, 0x5000f
    s_lshl_b32 s94, s94, 10
    s_add_u32 s95, s94, s83
    s_add_u32 s94, s94, s82
    buffer_load_dwordx4 v[96:99], v161, s[48:51], s94 offen nt
    v_mfma_f32_32x32x16_bf16 v[56:71], v[76:79], v[140:143], v[56:71]
    buffer_load_dwordx4 v[100:103], v161, s[48:51], s95 offen nt
    s_waitcnt vmcnt(4)
    s_waitcnt lgkmcnt(0)
    v_mfma_f32_32x32x16_bf16 v[8:23], v[80:83], v[144:147], v[8:23]
    ds_read_b64_tr_b16 v[72:73], v162 offset:0
    ds_read_b64_tr_b16 v[74:75], v162 offset:1024
    v_mfma_f32_32x32x16_bf16 v[24:39], v[80:83], v[148:151], v[24:39]
    ds_read_b64_tr_b16 v[76:77], v163 offset:0
    ds_read_b64_tr_b16 v[78:79], v163 offset:1024
    v_mfma_f32_32x32x16_bf16 v[40:55], v[84:87], v[144:147], v[40:55]
    s_bfe_u32 s94, s89, 0x50014
    s_lshl_b32 s94, s94, 10
    s_add_u32 s95, s94, s83
    s_add_u32 s94, s94, s82
    buffer_load_dwordx4 v[104:107], v161, s[48:51], s94 offen nt
    v_mfma_f32_32x32x16_bf16 v[56:71], v[84:87], v[148:151], v[56:71]
    buffer_load_dwordx4 v[108:111], v161, s[48:51], s95 offen nt
    s_waitcnt vmcnt(4)
    s_waitcnt lgkmcnt(0)
    v_mfma_f32_32x32x16_bf16 v[8:23], v[72:75], v[88:91], v[8:23]
    ds_read_b64_tr_b16 v[80:81], v162 offset:2048
    ds_read_b64_tr_b16 v[82:83], v162 offset:3072
    v_mfma_f32_32x32x16_bf16 v[24:39], v[72:75], v[92:95], v[24:39]
    ds_read_b64_tr_b16 v[84:85], v163 offset:2048
    ds_read_b64_tr_b16 v[86:87], v163 offset:3072
    v_mfma_f32_32x32x16_bf16 v[40:55], v[76:79], v[88:91], v[40:55]
    s_bfe_u32 s94, s89, 0x50019
    s_lshl_b32 s94, s94, 10
    s_add_u32 s95, s94, s83
    s_add_u32 s94, s94, s82
    buffer_load_dwordx4 v[112:115], v161, s[48:51], s94 offen nt
    v_mfma_f32_32x32x16_bf16 v[56:71], v[76:79], v[92:95], v[56:71]
    buffer_load_dwordx4 v[116:119], v161, s[48:51], s95 offen nt
    buffer_load_dword v2, v166, s[48:51], s80 offen sc1
    s_waitcnt vmcnt(5)
    s_waitcnt lgkmcnt(0)
    v_mfma_f32_32x32x16_bf16 v[8:23], v[80:83], v[96:99], v[8:23]
    ds_read_b64_tr_b16 v[72:73], v5 offset:0
    ds_read_b64_tr_b16 v[74:75], v5 offset:1024
    v_mfma_f32_32x32x16_bf16 v[24:39], v[80:83], v[100:103], v[24:39]
    ds_read_b64_tr_b16 v[76:77], v7 offset:0
    ds_read_b64_tr_b16 v[78:79], v7 offset:1024
    v_mfma_f32_32x32x16_bf16 v[40:55], v[84:87], v[96:99], v[40:55]
    s_bfe_u32 s94, s90, 0x50000
    s_lshl_b32 s94, s94, 10
    s_add_u32 s95, s94, s83
    s_add_u32 s94, s94, s82
    buffer_load_dwordx4 v[120:123], v161, s[48:51], s94 offen nt
    v_mfma_f32_32x32x16_bf16 v[56:71], v[84:87], v[100:103], v[56:71]
    buffer_load_dwordx4 v[124:127], v161, s[48:51], s95 offen nt
    s_waitcnt vmcnt(5)
    s_waitcnt lgkmcnt(0)
    v_mfma_f32_32x32x16_bf16 v[8:23], v[72:75], v[104:107], v[8:23]
    ds_read_b64_tr_b16 v[80:81], v5 offset:2048
    ds_read_b64_tr_b16 v[82:83], v5 offset:3072
    v_mfma_f32_32x32x16_bf16 v[24:39], v[72:75], v[108:111], v[24:39]
    ds_read_b64_tr_b16 v[84:85], v7 offset:2048
    ds_read_b64_tr_b16 v[86:87], v7 offset:3072
    v_mfma_f32_32x32x16_bf16 v[40:55], v[76:79], v[104:107], v[40:55]
    s_bfe_u32 s94, s90, 0x50005
    s_lshl_b32 s94, s94, 10
    s_add_u32 s95, s94, s83
    s_add_u32 s94, s94, s82
    buffer_load_dwordx4 v[128:131], v161, s[48:51], s94 offen nt
    v_mfma_f32_32x32x16_bf16 v[56:71], v[76:79], v[108:111], v[56:71]
    buffer_load_dwordx4 v[132:135], v161, s[48:51], s95 offen nt
    s_waitcnt vmcnt(5)
    s_waitcnt lgkmcnt(0)
    v_mfma_f32_32x32x16_bf16 v[8:23], v[80:83], v[112:115], v[8:23]
    ds_read_b64_tr_b16 v[72:73], v5 offset:4096
    ds_read_b64_tr_b16 v[74:75], v5 offset:5120
    v_mfma_f32_32x32x16_bf16 v[24:39], v[80:83], v[116:119], v[24:39]
    ds_read_b64_tr_b16 v[76:77], v7 offset:4096
    ds_read_b64_tr_b16 v[78:79], v7 offset:5120
    v_mfma_f32_32x32x16_bf16 v[40:55], v[84:87], v[112:115], v[40:55]
    s_bfe_u32 s94, s90, 0x5000a
    s_lshl_b32 s94, s94, 10
    s_add_u32 s95, s94, s83
    s_add_u32 s94, s94, s82
    buffer_load_dwordx4 v[136:139], v161, s[48:51], s94 offen nt
    v_mfma_f32_32x32x16_bf16 v[56:71], v[84:87], v[116:119], v[56:71]
    buffer_load_dwordx4 v[140:143], v161, s[48:51], s95 offen nt
    s_waitcnt vmcnt(4)
    s_waitcnt lgkmcnt(0)
    v_mfma_f32_32x32x16_bf16 v[8:23], v[72:75], v[120:123], v[8:23]
    ds_read_b64_tr_b16 v[80:81], v5 offset:6144
    ds_read_b64_tr_b16 v[82:83], v5 offset:7168
    v_mfma_f32_32x32x16_bf16 v[24:39], v[72:75], v[124:127], v[24:39]
    ds_read_b64_tr_b16 v[84:85], v7 offset:6144
    ds_read_b64_tr_b16 v[86:87], v7 offset:7168
    v_mfma_f32_32x32x16_bf16 v[40:55], v[76:79], v[120:123], v[40:55]
    s_bfe_u32 s94, s90, 0x5000f
    s_lshl_b32 s94, s94, 10
    s_add_u32 s95, s94, s83
    s_add_u32 s94, s94, s82
    buffer_load_dwordx4 v[144:147], v161, s[48:51], s94 offen nt
    v_mfma_f32_32x32x16_bf16 v[56:71], v[76:79], v[124:127], v[56:71]
    buffer_load_dwordx4 v[148:151], v161, s[48:51], s95 offen nt
    s_waitcnt vmcnt(4)
    s_waitcnt lgkmcnt(0)
    v_mfma_f32_32x32x16_bf16 v[8:23], v[80:83], v[128:131], v[8:23]
    ds_read_b64_tr_b16 v[72:73], v5 offset:8192
    ds_read_b64_tr_b16 v[74:75], v5 offset:9216
    v_mfma_f32_32x32x16_bf16 v[24:39], v[80:83], v[132:135], v[24:39]
    ds_read_b64_tr_b16 v[76:77], v7 offset:8192
    ds_read_b64_tr_b16 v[78:79], v7 offset:9216
    v_mfma_f32_32x32x16_bf16 v[40:55], v[84:87], v[128:131], v[40:55]
    s_setprio 3
    v_cmp_ne_u32 vcc, s43, v2
    s_cbranch_vccz L_lateok_99
L_hpoll_100:
    buffer_load_dword v1, v166, s[48:51], s80 offen sc1
    s_waitcnt vmcnt(0)
    v_cmp_ne_u32 vcc, s43, v1
    s_cbranch_vccz L_hok_101
    s_sleep 4
    s_sub_u32 s86, s86, 1
    s_cbranch_scc0 L_hpoll_100
    s_mov_b32 s86, 0
L_hok_101:
L_lateok_99:
    s_setprio 0
    s_bfe_u32 s94, s90, 0x50014
    s_lshl_b32 s94, s94, 10
    s_add_u32 s95, s94, s83
    s_add_u32 s94, s94, s82
    buffer_load_dwordx4 v[88:91], v161, s[48:51], s94 offen nt
    v_mfma_f32_32x32x16_bf16 v[56:71], v[84:87], v[132:135], v[56:71]
    buffer_load_dwordx4 v[92:95], v161, s[48:51], s95 offen nt
    s_waitcnt vmcnt(4)
    s_waitcnt lgkmcnt(0)
    v_mfma_f32_32x32x16_bf16 v[8:23], v[72:75], v[136:139], v[8:23]
    ds_read_b64_tr_b16 v[80:81], v5 offset:10240
    ds_read_b64_tr_b16 v[82:83], v5 offset:11264
    s_bfe_u32 s93, s91, 0x50000
    s_lshl_b32 s93, s93, 14
    s_add_u32 m0, s14, 4096
    s_add_u32 s93, s93, s68
    buffer_load_dwordx4 v160, s[52:55], s93 offen lds
    v_mfma_f32_32x32x16_bf16 v[24:39], v[72:75], v[140:143], v[24:39]
    ds_read_b64_tr_b16 v[84:85], v7 offset:10240
    ds_read_b64_tr_b16 v[86:87], v7 offset:11264
    s_add_u32 m0, s14, 5120
    s_add_u32 s93, s93, 8192
    buffer_load_dwordx4 v160, s[52:55], s93 offen lds
    v_mfma_f32_32x32x16_bf16 v[40:55], v[76:79], v[136:139], v[40:55]
    s_bfe_u32 s94, s90, 0x50019
    s_lshl_b32 s94, s94, 10
    s_add_u32 s95, s94, s83
    s_add_u32 s94, s94, s82
    buffer_load_dwordx4 v[96:99], v161, s[48:51], s94 offen nt
    v_mfma_f32_32x32x16_bf16 v[56:71], v[76:79], v[140:143], v[56:71]
    buffer_load_dwordx4 v[100:103], v161, s[48:51], s95 offen nt
    s_waitcnt vmcnt(6)
    s_waitcnt lgkmcnt(0)
    v_mfma_f32_32x32x16_bf16 v[8:23], v[80:83], v[144:147], v[8:23]
    ds_read_b64_tr_b16 v[72:73], v5 offset:12288
    ds_read_b64_tr_b16 v[74:75], v5 offset:13312
    s_bfe_u32 s93, s91, 0x50005
    s_lshl_b32 s93, s93, 14
    s_add_u32 m0, s14, 6144
    s_add_u32 s93, s93, s68
    buffer_load_dwordx4 v160, s[52:55], s93 offen lds
    v_mfma_f32_32x32x16_bf16 v[24:39], v[80:83], v[148:151], v[24:39]
    ds_read_b64_tr_b16 v[76:77], v7 offset:12288
    ds_read_b64_tr_b16 v[78:79], v7 offset:13312
    s_add_u32 m0, s14, 7168
    s_add_u32 s93, s93, 8192
    buffer_load_dwordx4 v160, s[52:55], s93 offen lds
    v_mfma_f32_32x32x16_bf16 v[40:55], v[84:87], v[144:147], v[40:55]
    s_bfe_u32 s94, s91, 0x50000
    s_lshl_b32 s94, s94, 10
    s_add_u32 s95, s94, s83
    s_add_u32 s94, s94, s82
    buffer_load_dwordx4 v[104:107], v161, s[48:51], s94 offen nt
    v_mfma_f32_32x32x16_bf16 v[56:71], v[84:87], v[148:151], v[56:71]
    buffer_load_dwordx4 v[108:111], v161, s[48:51], s95 offen nt
    s_waitcnt vmcnt(8)
    s_waitcnt lgkmcnt(0)
    v_mfma_f32_32x32x16_bf16 v[8:23], v[72:75], v[88:91], v[8:23]
    ds_read_b64_tr_b16 v[80:81], v5 offset:14336
    ds_read_b64_tr_b16 v[82:83], v5 offset:15360
    s_bfe_u32 s93, s91, 0x5000a
    s_lshl_b32 s93, s93, 14
    s_add_u32 m0, s14, 8192
    s_add_u32 s93, s93, s68
    buffer_load_dwordx4 v160, s[52:55], s93 offen lds
    v_mfma_f32_32x32x16_bf16 v[24:39], v[72:75], v[92:95], v[24:39]
    ds_read_b64_tr_b16 v[84:85], v7 offset:14336
    ds_read_b64_tr_b16 v[86:87], v7 offset:15360
    s_add_u32 m0, s14, 9216
    s_add_u32 s93, s93, 8192
    buffer_load_dwordx4 v160, s[52:55], s93 offen lds
    v_mfma_f32_32x32x16_bf16 v[40:55], v[76:79], v[88:91], v[40:55]
    s_bfe_u32 s94, s91, 0x50005
    s_lshl_b32 s94, s94, 10
    s_add_u32 s95, s94, s83
    s_add_u32 s94, s94, s82
    buffer_load_dwordx4 v[112:115], v161, s[48:51], s94 offen nt
    v_mfma_f32_32x32x16_bf16 v[56:71], v[76:79], v[92:95], v[56:71]
    buffer_load_dwordx4 v[116:119], v161, s[48:51], s95 offen nt
    s_waitcnt vmcnt(8)
    s_waitcnt lgkmcnt(0)
    v_mfma_f32_32x32x16_bf16 v[8:23], v[80:83], v[96:99], v[8:23]
    ds_read_b64_tr_b16 v[72:73], v162 offset:4096
    ds_read_b64_tr_b16 v[74:75], v162 offset:5120
    s_bfe_u32 s93, s91, 0x5000f
    s_lshl_b32 s93, s93, 14
    s_add_u32 m0, s14, 10240
    s_add_u32 s93, s93, s68
    buffer_load_dwordx4 v160, s[52:55], s93 offen lds
    v_mfma_f32_32x32x16_bf16 v[24:39], v[80:83], v[100:103], v[24:39]
    ds_read_b64_tr_b16 v[76:77], v163 offset:4096
    ds_read_b64_tr_b16 v[78:79], v163 offset:5120
    s_add_u32 m0, s14, 11264
    s_add_u32 s93, s93, 8192
    buffer_load_dwordx4 v160, s[52:55], s93 offen lds
    v_mfma_f32_32x32x16_bf16 v[40:55], v[84:87], v[96:99], v[40:55]
    s_bfe_u32 s94, s91, 0x5000a
    s_lshl_b32 s94, s94, 10
    s_add_u32 s95, s94, s83
    s_add_u32 s94, s94, s82
    buffer_load_dwordx4 v[120:123], v161, s[48:51], s94 offen nt
    v_mfma_f32_32x32x16_bf16 v[56:71], v[84:87], v[100:103], v[56:71]
    buffer_load_dwordx4 v[124:127], v161, s[48:51], s95 offen nt
    v_mov_b32 v1, 0x1000000
    s_mov_b64 exec, 1
    ds_add_u32 v164, v1 offset:24
    s_mov_b64 exec, -1
    s_waitcnt vmcnt(8)
    s_waitcnt lgkmcnt(1)
    v_mfma_f32_32x32x16_bf16 v[8:23], v[72:75], v[104:107], v[8:23]
    ds_read_b64_tr_b16 v[80:81], v162 offset:6144
    ds_read_b64_tr_b16 v[82:83], v162 offset:7168
    s_bfe_u32 s93, s91, 0x50014
    s_lshl_b32 s93, s93, 14
    s_add_u32 m0, s14, 12288
    s_add_u32 s93, s93, s68
    buffer_load_dwordx4 v160, s[52:55], s93 offen lds
    v_mfma_f32_32x32x16_bf16 v[24:39], v[72:75], v[108:111], v[24:39]
    ds_read_b64_tr_b16 v[84:85], v163 offset:6144
    ds_read_b64_tr_b16 v[86:87], v163 offset:7168
    s_add_u32 m0, s14, 13312
    s_add_u32 s93, s93, 8192
    buffer_load_dwordx4 v160, s[52:55], s93 offen lds
    v_mfma_f32_32x32x16_bf16 v[40:55], v[76:79], v[104:107], v[40:55]
    s_bfe_u32 s94, s91, 0x5000f
    s_lshl_b32 s94, s94, 10
    s_add_u32 s95, s94, s83
    s_add_u32 s94, s94, s82
    buffer_load_dwordx4 v[128:131], v161, s[48:51], s94 offen nt
    v_mfma_f32_32x32x16_bf16 v[56:71], v[76:79], v[108:111], v[56:71]
    buffer_load_dwordx4 v[132:135], v161, s[48:51], s95 offen nt
    s_waitcnt vmcnt(8)
    s_waitcnt lgkmcnt(0)
    v_mfma_f32_32x32x16_bf16 v[8:23], v[80:83], v[112:115], v[8:23]
    ds_read_b64_tr_b16 v[72:73], v162 offset:8192
    ds_read_b64_tr_b16 v[74:75], v162 offset:9216
    s_bfe_u32 s93, s91, 0x50019
    s_lshl_b32 s93, s93, 14
    s_add_u32 m0, s14, 14336
    s_add_u32 s93, s93, s68
    buffer_load_dwordx4 v160, s[52:55], s93 offen lds
    v_mfma_f32_32x32x16_bf16 v[24:39], v[80:83], v[116:119], v[24:39]
    ds_read_b64_tr_b16 v[76:77], v163 offset:8192
    ds_read_b64_tr_b16 v[78:79], v163 offset:9216
    s_add_u32 m0, s14, 15360
    s_add_u32 s93, s93, 8192
    buffer_load_dwordx4 v160, s[52:55], s93 offen lds
    v_mfma_f32_32x32x16_bf16 v[40:55], v[84:87], v[112:115], v[40:55]
    s_bfe_u32 s94, s91, 0x50014
    s_lshl_b32 s94, s94, 10
    s_add_u32 s95, s94, s83
    s_add_u32 s94, s94, s82
    buffer_load_dwordx4 v[136:139], v161, s[48:51], s94 offen nt
    v_mfma_f32_32x32x16_bf16 v[56:71], v[84:87], v[116:119], v[56:71]
    buffer_load_dwordx4 v[140:143], v161, s[48:51], s95 offen nt
    s_waitcnt vmcnt(8)
    s_waitcnt lgkmcnt(0)
    v_mfma_f32_32x32x16_bf16 v[8:23], v[72:75], v[120:123], v[8:23]
    ds_read_b64_tr_b16 v[80:81], v162 offset:10240
    ds_read_b64_tr_b16 v[82:83], v162 offset:11264
    s_bfe_u32 s93, s92, 0x50000
    s_lshl_b32 s93, s93, 14
    s_add_u32 m0, s14, 16384
    s_add_u32 s93, s93, s68
    buffer_load_dwordx4 v160, s[52:55], s93 offen lds
    v_mfma_f32_32x32x16_bf16 v[24:39], v[72:75], v[124:127], v[24:39]
    ds_read_b64_tr_b16 v[84:85], v163 offset:10240
    ds_read_b64_tr_b16 v[86:87], v163 offset:11264
    s_add_u32 m0, s14, 17408
    s_add_u32 s93, s93, 8192
    buffer_load_dwordx4 v160, s[52:55], s93 offen lds
    v_mfma_f32_32x32x16_bf16 v[40:55], v[76:79], v[120:123], v[40:55]
    s_bfe_u32 s94, s91, 0x50019
    s_lshl_b32 s94, s94, 10
    s_add_u32 s95, s94, s83
    s_add_u32 s94, s94, s82
    buffer_load_dwordx4 v[144:147], v161, s[48:51], s94 offen nt
    v_mfma_f32_32x32x16_bf16 v[56:71], v[76:79], v[124:127], v[56:71]
    buffer_load_dwordx4 v[148:151], v161, s[48:51], s95 offen nt
    s_waitcnt vmcnt(8)
    s_waitcnt lgkmcnt(0)
    v_mfma_f32_32x32x16_bf16 v[8:23], v[80:83], v[128:131], v[8:23]
    ds_read_b64_tr_b16 v[72:73], v162 offset:12288
    ds_read_b64_tr_b16 v[74:75], v162 offset:13312
    s_bfe_u32 s93, s92, 0x50005
    s_lshl_b32 s93, s93, 14
    s_add_u32 m0, s14, 18432
    s_add_u32 s93, s93, s68
    buffer_load_dwordx4 v160, s[52:55], s93 offen lds
    v_mfma_f32_32x32x16_bf16 v[24:39], v[80:83], v[132:135], v[24:39]
    ds_read_b64_tr_b16 v[76:77], v163 offset:12288
    ds_read_b64_tr_b16 v[78:79], v163 offset:13312
    s_add_u32 m0, s14, 19456
    s_add_u32 s93, s93, 8192
    buffer_load_dwordx4 v160, s[52:55], s93 offen lds
    v_mfma_f32_32x32x16_bf16 v[40:55], v[84:87], v[128:131], v[40:55]
    s_bfe_u32 s94, s92, 0x50000
    s_lshl_b32 s94, s94, 10
    s_add_u32 s95, s94, s83
    s_add_u32 s94, s94, s82
    buffer_load_dwordx4 v[88:91], v161, s[48:51], s94 offen nt
    v_mfma_f32_32x32x16_bf16 v[56:71], v[84:87], v[132:135], v[56:71]
    buffer_load_dwordx4 v[92:95], v161, s[48:51], s95 offen nt
    s_waitcnt vmcnt(8)
    s_waitcnt lgkmcnt(0)
    v_mfma_f32_32x32x16_bf16 v[8:23], v[72:75], v[136:139], v[8:23]
    ds_read_b64_tr_b16 v[80:81], v162 offset:14336
    ds_read_b64_tr_b16 v[82:83], v162 offset:15360
    s_bfe_u32 s93, s92, 0x5000a
    s_lshl_b32 s93, s93, 14
    s_add_u32 m0, s14, 0
    s_add_u32 s93, s93, s68
    buffer_load_dwordx4 v160, s[52:55], s93 offen lds
    v_mfma_f32_32x32x16_bf16 v[24:39], v[72:75], v[140:143], v[24:39]
    ds_read_b64_tr_b16 v[84:85], v163 offset:14336
    ds_read_b64_tr_b16 v[86:87], v163 offset:15360
    s_add_u32 m0, s14, 1024
    s_add_u32 s93, s93, 8192
    buffer_load_dwordx4 v160, s[52:55], s93 offen lds
    v_mfma_f32_32x32x16_bf16 v[40:55], v[76:79], v[136:139], v[40:55]
    s_bfe_u32 s94, s92, 0x50005
    s_lshl_b32 s94, s94, 10
    s_add_u32 s95, s94, s83
    s_add_u32 s94, s94, s82
    buffer_load_dwordx4 v[96:99], v161, s[48:51], s94 offen nt
    v_mfma_f32_32x32x16_bf16 v[56:71], v[76:79], v[140:143], v[56:71]
    buffer_load_dwordx4 v[100:103], v161, s[48:51], s95 offen nt
    s_waitcnt vmcnt(8)
    s_waitcnt lgkmcnt(0)
    v_mfma_f32_32x32x16_bf16 v[8:23], v[80:83], v[144:147], v[8:23]
    ds_read_b64_tr_b16 v[72:73], v162 offset:16384
    ds_read_b64_tr_b16 v[74:75], v162 offset:17408
    s_bfe_u32 s93, s92, 0x5000f
    s_lshl_b32 s93, s93, 14
    s_add_u32 m0, s14, 2048
    s_add_u32 s93, s93, s68
    buffer_load_dwordx4 v160, s[52:55], s93 offen lds
    v_mfma_f32_32x32x16_bf16 v[24:39], v[80:83], v[148:151], v[24:39]
    ds_read_b64_tr_b16 v[76:77], v163 offset:16384
    ds_read_b64_tr_b16 v[78:79], v163 offset:17408
    s_add_u32 m0, s14, 3072
    s_add_u32 s93, s93, 8192
    buffer_load_dwordx4 v160, s[52:55], s93 offen lds
    s_add_u32 m0, s14, 4096
    s_add_u32 s93, s69, 32768
    buffer_load_dwordx4 v160, s[56:59], s93 offen lds
    v_mfma_f32_32x32x16_bf16 v[40:55], v[84:87], v[144:147], v[40:55]
    s_bfe_u32 s94, s92, 0x5000a
    s_lshl_b32 s94, s94, 10
    s_add_u32 s95, s94, s83
    s_add_u32 s94, s94, s82
    buffer_load_dwordx4 v[104:107], v161, s[48:51], s94 offen nt
    v_mfma_f32_32x32x16_bf16 v[56:71], v[84:87], v[148:151], v[56:71]
    buffer_load_dwordx4 v[108:111], v161, s[48:51], s95 offen nt
    s_waitcnt vmcnt(9)
    s_waitcnt lgkmcnt(0)
    v_mfma_f32_32x32x16_bf16 v[8:23], v[72:75], v[88:91], v[8:23]
    ds_read_b64_tr_b16 v[80:81], v162 offset:18432
    ds_read_b64_tr_b16 v[82:83], v162 offset:19456
    s_add_u32 m0, s14, 5120
    s_add_u32 s93, s93, 8192
    buffer_load_dwordx4 v160, s[56:59], s93 offen lds
    s_add_u32 m0, s14, 6144
    s_add_u32 s93, s69, 49152
    buffer_load_dwordx4 v160, s[56:59], s93 offen lds
    v_mfma_f32_32x32x16_bf16 v[24:39], v[72:75], v[92:95], v[24:39]
    ds_read_b64_tr_b16 v[84:85], v163 offset:18432
    ds_read_b64_tr_b16 v[86:87], v163 offset:19456
    s_add_u32 m0, s14, 7168
    s_add_u32 s93, s93, 8192
    buffer_load_dwordx4 v160, s[56:59], s93 offen lds
    s_add_u32 m0, s14, 8192
    s_add_u32 s93, s69, 98304
    buffer_load_dwordx4 v160, s[56:59], s93 offen lds
    v_mfma_f32_32x32x16_bf16 v[40:55], v[76:79], v[88:91], v[40:55]
    s_bfe_u32 s94, s92, 0x5000f
    s_lshl_b32 s94, s94, 10
    s_add_u32 s95, s94, s83
    s_add_u32 s94, s94, s82
    buffer_load_dwordx4 v[112:115], v161, s[48:51], s94 offen nt
    v_mfma_f32_32x32x16_bf16 v[56:71], v[76:79], v[92:95], v[56:71]
    buffer_load_dwordx4 v[116:119], v161, s[48:51], s95 offen nt
    s_waitcnt vmcnt(11)
    s_waitcnt lgkmcnt(0)
    v_mfma_f32_32x32x16_bf16 v[8:23], v[80:83], v[96:99], v[8:23]
    ds_read_b64_tr_b16 v[72:73], v162 offset:0
    ds_read_b64_tr_b16 v[74:75], v162 offset:1024
    s_add_u32 m0, s14, 9216
    s_add_u32 s93, s93, 8192
    buffer_load_dwordx4 v160, s[56:59], s93 offen lds
    s_add_u32 m0, s14, 10240
    s_add_u32 s93, s69, 114688
    buffer_load_dwordx4 v160, s[56:59], s93 offen lds
    v_mfma_f32_32x32x16_bf16 v[24:39], v[80:83], v[100:103], v[24:39]
    ds_read_b64_tr_b16 v[76:77], v163 offset:0
    ds_read_b64_tr_b16 v[78:79], v163 offset:1024
    s_add_u32 m0, s14, 11264
    s_add_u32 s93, s93, 8192
    buffer_load_dwordx4 v160, s[56:59], s93 offen lds
    s_add_u32 m0, s14, 12288
    s_add_u32 s93, s69, 0
    buffer_load_dwordx4 v160, s[56:59], s93 offen lds
    v_mfma_f32_32x32x16_bf16 v[40:55], v[84:87], v[96:99], v[40:55]
    v_mfma_f32_32x32x16_bf16 v[56:71], v[84:87], v[100:103], v[56:71]
    v_and_b32 v4, 31, v0
    v_mul_u32_u24 v4, 272, v4
    v_lshrrev_b32 v5, 5, v0
    v_lshlrev_b32 v5, 4, v5
    v_add3_u32 v4, v4, v5, s14
    s_waitcnt vmcnt(10)
    s_waitcnt lgkmcnt(0)
    v_mfma_f32_32x32x16_bf16 v[8:23], v[72:75], v[104:107], v[8:23]
    ds_read_b64_tr_b16 v[80:81], v162 offset:2048
    ds_read_b64_tr_b16 v[82:83], v162 offset:3072
    s_add_u32 m0, s14, 13312
    s_add_u32 s93, s93, 8192
    buffer_load_dwordx4 v160, s[56:59], s93 offen lds
    s_add_u32 m0, s14, 14336
    s_add_u32 s93, s69, 16384
    buffer_load_dwordx4 v160, s[56:59], s93 offen lds
    v_mfma_f32_32x32x16_bf16 v[24:39], v[72:75], v[108:111], v[24:39]
    ds_read_b64_tr_b16 v[84:85], v163 offset:2048
    ds_read_b64_tr_b16 v[86:87], v163 offset:3072
    s_add_u32 m0, s14, 15360
    s_add_u32 s93, s93, 8192
    buffer_load_dwordx4 v160, s[56:59], s93 offen lds
    s_add_u32 m0, s14, 16384
    s_add_u32 s93, s69, 65536
    buffer_load_dwordx4 v160, s[56:59], s93 offen lds
    v_mfma_f32_32x32x16_bf16 v[40:55], v[76:79], v[104:107], v[40:55]
    v_mfma_f32_32x32x16_bf16 v[56:71], v[76:79], v[108:111], v[56:71]
    s_setprio 3
L_spin_102:
    ds_read_b32 v1, v164 offset:28
    s_waitcnt lgkmcnt(0)
    v_readfirstlane_b32 s6, v1
    s_nop 0
    s_bfe_u32 s7, s6, 0x80008
    s_cmp_ge_u32 s7, 4
    s_cbranch_scc1 L_spun_103
    s_sleep 1
    s_sub_u32 s86, s86, 1
    s_cbranch_scc0 L_spin_102
    s_mov_b32 s86, 0
L_spun_103:
    s_add_u32 s94, s84, 2048
    s_add_u32 s95, s85, 2048
    buffer_load_dwordx4 v[120:123], v161, s[48:51], s94 offen nt
    buffer_load_dwordx4 v[124:127], v161, s[48:51], s95 offen nt
    s_add_u32 s94, s84, 3072
    s_add_u32 s95, s85, 3072
    buffer_load_dwordx4 v[128:131], v161, s[48:51], s94 offen nt
    buffer_load_dwordx4 v[132:135], v161, s[48:51], s95 offen nt
    s_add_u32 s94, s84, 6144
    s_add_u32 s95, s85, 6144
    buffer_load_dwordx4 v[136:139], v161, s[48:51], s94 offen nt
    buffer_load_dwordx4 v[140:143], v161, s[48:51], s95 offen nt
    s_add_u32 s94, s84, 7168
    s_add_u32 s95, s85, 7168
    buffer_load_dwordx4 v[144:147], v161, s[48:51], s94 offen nt
    buffer_load_dwordx4 v[148:151], v161, s[48:51], s95 offen nt
    s_setprio 0
    s_waitcnt vmcnt(16)
    v_mfma_f32_32x32x16_bf16 v[8:23], v[80:83], v[112:115], v[8:23]
    ds_read_b64_tr_b16 v[72:73], v162 offset:4096
    ds_read_b64_tr_b16 v[74:75], v162 offset:5120
    s_add_u32 m0, s14, 17408
    s_add_u32 s93, s93, 8192
    buffer_load_dwordx4 v160, s[56:59], s93 offen lds
    s_add_u32 m0, s14, 18432
    s_add_u32 s93, s69, 81920
    buffer_load_dwordx4 v160, s[56:59], s93 offen lds
    v_mfma_f32_32x32x16_bf16 v[24:39], v[80:83], v[116:119], v[24:39]
    ds_read_b64_tr_b16 v[76:77], v163 offset:4096
    ds_read_b64_tr_b16 v[78:79], v163 offset:5120
    s_add_u32 m0, s14, 19456
    s_add_u32 s93, s93, 8192
    buffer_load_dwordx4 v160, s[56:59], s93 offen lds
    v_mfma_f32_32x32x16_bf16 v[40:55], v[84:87], v[112:115], v[40:55]
    v_mfma_f32_32x32x16_bf16 v[56:71], v[84:87], v[116:119], v[56:71]
    s_setprio 3
    s_waitcnt vmcnt(7)
L_ock_104:
    v_max3_u32 v1, v120, v121, v122
    v_max3_u32 v3, v123, v124, v125
    v_max3_u32 v1, v126, v127, v1
    v_max3_u32 v3, v128, v129, v3
    v_max3_u32 v1, v130, v131, v1
    v_max3_u32 v3, v132, v133, v3
    v_max3_u32 v1, v134, v135, v1
    v_max_u32 v1, v1, v3
    v_cmp_eq_u32 vcc, -1, v1
    s_cbranch_vccz L_ook_105
    s_add_u32 s8, s84, 2048
    s_add_u32 s9, s85, 2048
    buffer_load_dwordx4 v[120:123], v161, s[48:51], s8 offen sc1
    buffer_load_dwordx4 v[124:127], v161, s[48:51], s9 offen sc1
    s_add_u32 s8, s84, 3072
    s_add_u32 s9, s85, 3072
    buffer_load_dwordx4 v[128:131], v161, s[48:51], s8 offen sc1
    buffer_load_dwordx4 v[132:135], v161, s[48:51], s9 offen sc1
    s_add_u32 s8, s84, 6144
    s_add_u32 s9, s85, 6144
    buffer_load_dwordx4 v[136:139], v161, s[48:51], s8 offen sc1
    buffer_load_dwordx4 v[140:143], v161, s[48:51], s9 offen sc1
    s_add_u32 s8, s84, 7168
    s_add_u32 s9, s85, 7168
    buffer_load_dwordx4 v[144:147], v161, s[48:51], s8 offen sc1
    buffer_load_dwordx4 v[148:151], v161, s[48:51], s9 offen sc1
    s_waitcnt vmcnt(0)
    s_sub_u32 s86, s86, 1
    s_cbranch_scc0 L_ock_104
    s_mov_b32 s86, 0
L_ook_105:
    s_waitcnt lgkmcnt(0)
    v_mfma_f32_32x32x16_bf16 v[8:23], v[72:75], v[120:123], v[8:23]
    ds_read_b64_tr_b16 v[80:81], v162 offset:6144
    ds_read_b64_tr_b16 v[82:83], v162 offset:7168
    v_mfma_f32_32x32x16_bf16 v[24:39], v[72:75], v[124:127], v[24:39]
    ds_read_b64_tr_b16 v[84:85], v163 offset:6144
    ds_read_b64_tr_b16 v[86:87], v163 offset:7168
    v_mfma_f32_32x32x16_bf16 v[40:55], v[76:79], v[120:123], v[40:55]
    v_mfma_f32_32x32x16_bf16 v[56:71], v[76:79], v[124:127], v[56:71]
    s_waitcnt lgkmcnt(0)
    v_mfma_f32_32x32x16_bf16 v[8:23], v[80:83], v[128:131], v[8:23]
    ds_read_b64_tr_b16 v[72:73], v162 offset:8192
    ds_read_b64_tr_b16 v[74:75], v162 offset:9216
    v_mfma_f32_32x32x16_bf16 v[24:39], v[80:83], v[132:135], v[24:39]
    ds_read_b64_tr_b16 v[76:77], v163 offset:8192
    ds_read_b64_tr_b16 v[78:79], v163 offset:9216
    v_mfma_f32_32x32x16_bf16 v[40:55], v[84:87], v[128:131], v[40:55]
    v_mfma_f32_32x32x16_bf16 v[56:71], v[84:87], v[132:135], v[56:71]
L_spin_106:
    ds_read_b32 v1, v164 offset:28
    s_waitcnt lgkmcnt(0)
    v_readfirstlane_b32 s6, v1
    s_nop 0
    s_bfe_u32 s7, s6, 0x80000
    s_cmp_ge_u32 s7, 4
    s_cbranch_scc1 L_spun_107
    s_sleep 1
    s_sub_u32 s86, s86, 1
    s_cbranch_scc0 L_spin_106
    s_mov_b32 s86, 0
L_spun_107:
    s_add_u32 s94, s84, 0
    s_add_u32 s95, s85, 0
    buffer_load_dwordx4 v[88:91], v161, s[48:51], s94 offen nt
    buffer_load_dwordx4 v[92:95], v161, s[48:51], s95 offen nt
    s_add_u32 s94, s84, 1024
    s_add_u32 s95, s85, 1024
    buffer_load_dwordx4 v[96:99], v161, s[48:51], s94 offen nt
    buffer_load_dwordx4 v[100:103], v161, s[48:51], s95 offen nt
    s_add_u32 s94, s84, 4096
    s_add_u32 s95, s85, 4096
    buffer_load_dwordx4 v[104:107], v161, s[48:51], s94 offen nt
    buffer_load_dwordx4 v[108:111], v161, s[48:51], s95 offen nt
    s_add_u32 s94, s84, 5120
    s_add_u32 s95, s85, 5120
    buffer_load_dwordx4 v[112:115], v161, s[48:51], s94 offen nt
    buffer_load_dwordx4 v[116:119], v161, s[48:51], s95 offen nt
    s_waitcnt vmcnt(11)
L_ock_108:
    v_max3_u32 v1, v136, v137, v138
    v_max3_u32 v3, v139, v140, v141
    v_max3_u32 v1, v142, v143, v1
    v_max3_u32 v3, v144, v145, v3
    v_max3_u32 v1, v146, v147, v1
    v_max3_u32 v3, v148, v149, v3
    v_max3_u32 v1, v150, v151, v1
    v_max_u32 v1, v1, v3
    v_cmp_eq_u32 vcc, -1, v1
    s_cbranch_vccz L_ook_109
    s_add_u32 s8, s84, 6144
    s_add_u32 s9, s85, 6144
    buffer_load_dwordx4 v[136:139], v161, s[48:51], s8 offen sc1
    buffer_load_dwordx4 v[140:143], v161, s[48:51], s9 offen sc1
    s_add_u32 s8, s84, 7168
    s_add_u32 s9, s85, 7168
    buffer_load_dwordx4 v[144:147], v161, s[48:51], s8 offen sc1
    buffer_load_dwordx4 v[148:151], v161, s[48:51], s9 offen sc1
    s_waitcnt vmcnt(0)
    s_sub_u32 s86, s86, 1
    s_cbranch_scc0 L_ock_108
    s_mov_b32 s86, 0
L_ook_109:
    v_mfma_f32_32x32x16_bf16 v[8:23], v[72:75], v[136:139], v[8:23]
    ds_read_b64_tr_b16 v[80:81], v162 offset:10240
    ds_read_b64_tr_b16 v[82:83], v162 offset:11264
    v_mfma_f32_32x32x16_bf16 v[24:39], v[72:75], v[140:143], v[24:39]
    ds_read_b64_tr_b16 v[84:85], v163 offset:10240
    ds_read_b64_tr_b16 v[86:87], v163 offset:11264
    v_mfma_f32_32x32x16_bf16 v[40:55], v[76:79], v[136:139], v[40:55]
    v_mfma_f32_32x32x16_bf16 v[56:71], v[76:79], v[140:143], v[56:71]
    s_waitcnt lgkmcnt(0)
    v_mfma_f32_32x32x16_bf16 v[8:23], v[80:83], v[144:147], v[8:23]
    ds_read_b64_tr_b16 v[72:73], v162 offset:12288
    ds_read_b64_tr_b16 v[74:75], v162 offset:13312
    v_mfma_f32_32x32x16_bf16 v[24:39], v[80:83], v[148:151], v[24:39]
    ds_read_b64_tr_b16 v[76:77], v163 offset:12288
    ds_read_b64_tr_b16 v[78:79], v163 offset:13312
    v_mfma_f32_32x32x16_bf16 v[40:55], v[84:87], v[144:147], v[40:55]
    v_mfma_f32_32x32x16_bf16 v[56:71], v[84:87], v[148:151], v[56:71]
    s_waitcnt vmcnt(4)
L_ock_110:
    v_max3_u32 v1, v88, v89, v90
    v_max3_u32 v3, v91, v92, v93
    v_max3_u32 v1, v94, v95, v1
    v_max3_u32 v3, v96, v97, v3
    v_max3_u32 v1, v98, v99, v1
    v_max3_u32 v3, v100, v101, v3
    v_max3_u32 v1, v102, v103, v1
    v_max_u32 v1, v1, v3
    v_cmp_eq_u32 vcc, -1, v1
    s_cbranch_vccz L_ook_111
    s_add_u32 s8, s84, 0
    s_add_u32 s9, s85, 0
    buffer_load_dwordx4 v[88:91], v161, s[48:51], s8 offen sc1
    buffer_load_dwordx4 v[92:95], v161, s[48:51], s9 offen sc1
    s_add_u32 s8, s84, 1024
    s_add_u32 s9, s85, 1024
    buffer_load_dwordx4 v[96:99], v161, s[48:51], s8 offen sc1
    buffer_load_dwordx4 v[100:103], v161, s[48:51], s9 offen sc1
    s_add_u32 s8, s84, 4096
    s_add_u32 s9, s85, 4096
    buffer_load_dwordx4 v[104:107], v161, s[48:51], s8 offen sc1
    buffer_load_dwordx4 v[108:111], v161, s[48:51], s9 offen sc1
    s_add_u32 s8, s84, 5120
    s_add_u32 s9, s85, 5120
    buffer_load_dwordx4 v[112:115], v161, s[48:51], s8 offen sc1
    buffer_load_dwordx4 v[116:119], v161, s[48:51], s9 offen sc1
    s_waitcnt vmcnt(0)
    s_sub_u32 s86, s86, 1
    s_cbranch_scc0 L_ock_110
    s_mov_b32 s86, 0
L_ook_111:
    s_waitcnt lgkmcnt(0)
    v_mfma_f32_32x32x16_bf16 v[8:23], v[72:75], v[88:91], v[8:23]
    ds_read_b64_tr_b16 v[80:81], v162 offset:14336
    ds_read_b64_tr_b16 v[82:83], v162 offset:15360
    v_mfma_f32_32x32x16_bf16 v[24:39], v[72:75], v[92:95], v[24:39]
    ds_read_b64_tr_b16 v[84:85], v163 offset:14336
    ds_read_b64_tr_b16 v[86:87], v163 offset:15360
    v_mfma_f32_32x32x16_bf16 v[40:55], v[76:79], v[88:91], v[40:55]
    v_mfma_f32_32x32x16_bf16 v[56:71], v[76:79], v[92:95], v[56:71]
    s_waitcnt lgkmcnt(0)
    v_mfma_f32_32x32x16_bf16 v[8:23], v[80:83], v[96:99], v[8:23]
    ds_read_b64_tr_b16 v[72:73], v162 offset:16384
    ds_read_b64_tr_b16 v[74:75], v162 offset:17408
    v_mfma_f32_32x32x16_bf16 v[24:39], v[80:83], v[100:103], v[24:39]
    ds_read_b64_tr_b16 v[76:77], v163 offset:16384
    ds_read_b64_tr_b16 v[78:79], v163 offset:17408
    v_mfma_f32_32x32x16_bf16 v[40:55], v[84:87], v[96:99], v[40:55]
    v_mfma_f32_32x32x16_bf16 v[56:71], v[84:87], v[100:103], v[56:71]
    s_waitcnt vmcnt(0)
L_ock_112:
    v_max3_u32 v1, v104, v105, v106
    v_max3_u32 v3, v107, v108, v109
    v_max3_u32 v1, v110, v111, v1
    v_max3_u32 v3, v112, v113, v3
    v_max3_u32 v1, v114, v115, v1
    v_max3_u32 v3, v116, v117, v3
    v_max3_u32 v1, v118, v119, v1
    v_max_u32 v1, v1, v3
    v_cmp_eq_u32 vcc, -1, v1
    s_cbranch_vccz L_ook_113
    s_add_u32 s8, s84, 4096
    s_add_u32 s9, s85, 4096
    buffer_load_dwordx4 v[104:107], v161, s[48:51], s8 offen sc1
    buffer_load_dwordx4 v[108:111], v161, s[48:51], s9 offen sc1
    s_add_u32 s8, s84, 5120
    s_add_u32 s9, s85, 5120
    buffer_load_dwordx4 v[112:115], v161, s[48:51], s8 offen sc1
    buffer_load_dwordx4 v[116:119], v161, s[48:51], s9 offen sc1
    s_waitcnt vmcnt(0)
    s_sub_u32 s86, s86, 1
    s_cbranch_scc0 L_ock_112
    s_mov_b32 s86, 0
L_ook_113:
    ds_read_b64_tr_b16 v[80:81], v162 offset:18432
    ds_read_b64_tr_b16 v[82:83], v162 offset:19456
    ds_read_b64_tr_b16 v[84:85], v163 offset:18432
    ds_read_b64_tr_b16 v[86:87], v163 offset:19456
    s_waitcnt lgkmcnt(0)
    v_mfma_f32_32x32x16_bf16 v[8:23], v[72:75], v[104:107], v[8:23]
    v_mfma_f32_32x32x16_bf16 v[8:23], v[80:83], v[112:115], v[8:23]
    s_nop 5
    v_mfma_f32_32x32x16_bf16 v[24:39], v[72:75], v[108:111], v[24:39]
    s_nop 3
    v_mfma_f32_32x32x16_bf16 v[24:39], v[80:83], v[116:119], v[24:39]
    ds_write_b128 v4, v[8:11] offset:0
    ds_write_b128 v4, v[12:15] offset:32
    v_mfma_f32_32x32x16_bf16 v[40:55], v[76:79], v[104:107], v[40:55]
    ds_write_b128 v4, v[16:19] offset:64
    ds_write_b128 v4, v[20:23] offset:96
    v_mfma_f32_32x32x16_bf16 v[40:55], v[84:87], v[112:115], v[40:55]
    s_nop 4
    v_mfma_f32_32x32x16_bf16 v[56:71], v[76:79], v[108:111], v[56:71]
    ds_write_b128 v4, v[24:27] offset:8704
    ds_write_b128 v4, v[28:31] offset:8736
    v_mfma_f32_32x32x16_bf16 v[56:71], v[84:87], v[116:119], v[56:71]
    ds_write_b128 v4, v[32:35] offset:8768
    ds_write_b128 v4, v[36:39] offset:8800
    s_nop 0
    ds_write_b128 v4, v[40:43] offset:128
    ds_write_b128 v4, v[44:47] offset:160
    ds_write_b128 v4, v[48:51] offset:192
    ds_write_b128 v4, v[52:55] offset:224
    s_nop 4
    ds_write_b128 v4, v[56:59] offset:8832
    ds_write_b128 v4, v[60:63] offset:8864
    ds_write_b128 v4, v[64:67] offset:8896
    ds_write_b128 v4, v[68:71] offset:8928
    s_waitcnt lgkmcnt(0)
L_gskip:
    s_barrier
L_end:
L_code_end:
    s_endpgm
.section .rodata,"a"
.p2align 6
.amdhsa_kernel parallel_sum__grouped_kv_mqa__dense_activation_gelu__prompt_kernel
  .amdhsa_next_free_vgpr 168
  .amdhsa_next_free_sgpr 100
  .amdhsa_accum_offset 168
  .amdhsa_group_segment_fixed_size 0
  .amdhsa_kernarg_size 104
  .amdhsa_user_sgpr_count 2
  .amdhsa_user_sgpr_kernarg_segment_ptr 1
  .amdhsa_system_sgpr_workgroup_id_x 1
.end_amdhsa_kernel
```
